```python
import torch

def _softmax(x, axis=-1):
    return torch.softmax(x, dim=axis)
def _gelu(x):
    return torch.nn.functional.gelu(x, approximate="tanh")
def _silu(x):
    return torch.nn.functional.silu(x)
def _sigmoid(x):
    return torch.sigmoid(x)
def _layernorm(x, axis=-1, eps=1e-5):
    m = x.mean(dim=axis, keepdim=True)
    v = x.var(dim=axis, keepdim=True, unbiased=False)
    return (x - m) / torch.sqrt(v + eps)
def _scatter_add(tgt, idx, src, axis=0):
    return tgt.clone().index_add_(axis, idx, src)
def _segment_sum(src, seg, n):
    out = torch.zeros((n,) + src.shape[1:], dtype=src.dtype)
    return out.index_add_(0, seg, src)
def _pad(x, pw):
    flat = tuple(v for pair in reversed(pw) for v in pair)
    return torch.nn.functional.pad(x, flat)

kernel_name = 'concat_heads__compressed_kv_cla__mha_block_cached__decode'

def setup_inputs():

    _w = (lambda a: (lambda t: t.to(torch.bfloat16) if t.is_floating_point() else t)(torch.as_tensor(a)))
    def _A_setup():
        B, H, Sq, Sk, D, M = 2, 32, 1, 8192, 128, 512
        Dc = 4 * D
        return {
            "x": _w((lambda *s: torch.randn(*s, dtype=torch.bfloat16) * 3.2)(B, Sq, M)),
            "c_kv": _w((lambda *s: torch.randn(*s, dtype=torch.bfloat16) * 0.1)(B, Sk, Dc)),
            "w_q": _w((lambda *s: torch.randn(*s, dtype=torch.bfloat16) * 6.4)(M, H, D) * (M ** -0.5)),
            "w_uk": _w((lambda *s: torch.randn(*s, dtype=torch.bfloat16) * 6.4)(Dc, H, D) * (Dc ** -0.5)),
            "w_uv": _w((lambda *s: torch.randn(*s, dtype=torch.bfloat16) * 0.1)(Dc, H, D) * (Dc ** -0.5)),
            "w_o": _w((lambda *s: torch.randn(*s, dtype=torch.bfloat16) * 0.1)(H, D, M) * ((H * D) ** -0.5)),
        }
    _A_in = _A_setup()

    def _B_setup():
        B, Sq, D = 2, 1, 512
        H, Sk, Dh = 32, 8192, 128
        return {
            "x": _w((lambda *s: torch.randn(*s, dtype=torch.bfloat16) * 1.6)(B, Sq, D)),
            "k_cache": _w((lambda *s: torch.randn(*s, dtype=torch.bfloat16) * 1.6)(B, H, Sk, Dh)),
            "v_cache": _w((lambda *s: torch.randn(*s, dtype=torch.bfloat16) * 0.05)(B, H, Sk, Dh)),
            "wq": _w((lambda *s: torch.randn(*s, dtype=torch.bfloat16) * 1.6)(D, H * Dh) * (D ** -0.5)),
            "wo": _w((lambda *s: torch.randn(*s, dtype=torch.bfloat16) * 0.05)(H * Dh, D) * ((H * Dh) ** -0.5)),
        }
    _B_in = _B_setup()

    return {
        "A_x": _A_in["x"],
        "A_c_kv": _A_in["c_kv"],
        "A_w_q": _A_in["w_q"],
        "A_w_uk": _A_in["w_uk"],
        "A_w_uv": _A_in["w_uv"],
        "A_w_o": _A_in["w_o"],
        "B_x": _B_in["x"],
        "B_k_cache": _B_in["k_cache"],
        "B_v_cache": _B_in["v_cache"],
        "B_wq": _B_in["wq"],
        "B_wo": _B_in["wo"],
    }

def reference(A_x, A_c_kv, A_w_q, A_w_uk, A_w_uv, A_w_o, B_x, B_k_cache, B_v_cache, B_wq, B_wo):
    def _A_ref(x, c_kv, w_q, w_uk, w_uv, w_o):
        B, Sq, M = x.shape[0], x.shape[1], x.shape[2]
        Sk = c_kv.shape[1]
        H, D = w_q.shape[1], w_q.shape[2]
        q = torch.einsum("bqm,mhd->bhqd", x, w_q)
        k = torch.einsum("bkc,chd->bhkd", c_kv, w_uk)
        v = torch.einsum("bkc,chd->bhkd", c_kv, w_uv)
        scores = torch.einsum("bhqd,bhkd->bhqk", q, k) * (D ** -0.5)
        off = Sk - Sq
        qi = torch.arange(Sq)[:, None]
        kj = torch.arange(Sk)[None, :]
        cmask = kj <= (qi + off)
        scores = torch.where(cmask[None, None], scores, -1e9)
        p = _softmax(scores, axis=-1)
        ctx = torch.einsum("bhqk,bhkd->bhqd", p, v)
        return torch.einsum("bhqd,hdm->bqm", ctx, w_o)

    def _B_ref(x, k_cache, v_cache, wq, wo):
        B, Sq, D = x.shape
        H, Dh = 32, 128
        q = (lambda x, *d: x.permute(*d))((x @ wq).reshape(B, Sq, H, Dh), 0, 2, 1, 3)
        scores = torch.einsum("bhqd,bhkd->bhqk", q, k_cache) * (Dh ** -0.5)
        p = _softmax(scores, axis=-1)
        o = torch.einsum("bhqk,bhkd->bhqd", p, v_cache)
        return (lambda x, *d: x.permute(*d))(o, 0, 2, 1, 3).reshape(B, Sq, H * Dh) @ wo

    a = _A_ref(A_x, A_c_kv, A_w_q, A_w_uk, A_w_uv, A_w_o)
    b = _B_ref(B_x, B_k_cache, B_v_cache, B_wq, B_wo)
    return torch.concatenate([a, b], axis=-1)
```

```asm
; @launch kernel=main_kernel grid=(256,1,1) block=(512,1,1) lds=147456
; @launch kernel=final_kernel grid=(32,1,1) block=(512,1,1) lds=2048
.amdgcn_target "amdgcn-amd-amdhsa--gfx950"
.text
.globl main_kernel
.type main_kernel,@function
.globl final_kernel
.type final_kernel,@function
.p2align 8
main_kernel:
    s_cmp_ge_u32 s2, 256
    s_cbranch_scc1 L_main_end
    s_load_dwordx16 s[16:31], s[0:1], 0
    s_load_dwordx8 s[32:39], s[0:1], 64
    s_load_dwordx4 s[40:43], s[0:1], 96
    v_and_b32 v1, 63, v0
    v_lshrrev_b32 v8, 6, v0
    v_and_b32 v2, 15, v1
    v_readfirstlane_b32 s64, v8
    v_lshrrev_b32 v3, 4, v1
    s_mov_b32 s65, 0x3e0293ee
    v_and_b32 v8, 7, v1
    v_lshrrev_b32 v9, 1, v8
    v_and_b32 v8, 1, v8
    v_lshlrev_b32 v8, 4, v8
    v_mov_b32 v10, 0xffff
    v_lshlrev_b32 v10, v8, v10
    v_cmp_eq_u32 vcc, 0, v9
    s_nop 1
    v_cndmask_b32 v4, 0, v10, vcc
    v_cmp_eq_u32 vcc, 1, v9
    s_nop 1
    v_cndmask_b32 v5, 0, v10, vcc
    v_cmp_eq_u32 vcc, 2, v9
    s_nop 1
    v_cndmask_b32 v6, 0, v10, vcc
    v_cmp_eq_u32 vcc, 3, v9
    s_nop 1
    v_cndmask_b32 v7, 0, v10, vcc
    s_mov_b32 s80, 0x01000100
    s_mov_b32 s81, 0x03020302
    s_waitcnt lgkmcnt(0)
    s_cmp_lt_u32 s2, 64
    s_cbranch_scc1 L_main_A
    s_sub_u32 s66, s2, 64
    s_and_b32 s67, s66, 7
    s_lshr_b32 s68, s66, 3
    s_and_b32 s69, s68, 3
    s_lshl_b32 s69, s69, 3
    s_add_u32 s72, s67, s69
    s_lshr_b32 s68, s68, 2
    s_cmp_ge_u32 s68, 3
    s_cselect_b32 s73, 1, 0
    s_mul_i32 s69, s73, 3
    s_sub_u32 s74, s68, s69
    s_lshl_b32 s66, s73, 5
    s_add_u32 s66, s66, s72
    s_lshl_b32 s66, s66, 21
    s_mul_i32 s67, s74, 700416
    s_add_u32 s66, s66, s67
    s_lshl_b32 s67, s64, 12
    s_add_u32 s76, s66, s67
    s_cmp_eq_u32 s74, 2
    s_cselect_b32 s68, 1, 0
    s_sub_u32 s68, 171, s68
    s_sub_u32 s68, s68, s64
    s_add_u32 s77, s68, 7
    s_lshr_b32 s77, s77, 3
    s_add_u32 s44, s30, s76
    s_addc_u32 s45, s31, 0
    s_mov_b32 s46, 0x0
    s_mov_b32 s47, 0x00020000
    s_add_u32 s48, s32, s76
    s_addc_u32 s49, s33, 0
    s_mov_b32 s50, 0x0
    s_mov_b32 s51, 0x00020000
    s_lshl_b32 s46, s68, 12
    s_lshl_b32 s50, s68, 12
    s_mov_b32 s52, s28
    s_mov_b32 s53, s29
    s_mov_b32 s54, 0x800
    s_mov_b32 s55, 0x00020000
    s_lshl_b32 s76, s72, 8
    s_add_u32 s56, s34, s76
    s_addc_u32 s57, s35, 0
    s_mov_b32 s58, 0x0
    s_mov_b32 s59, 0x00020000
    s_sub_u32 s58, 4194304, s76
    s_lshl_b32 s76, s72, 17
    s_add_u32 s60, s36, s76
    s_addc_u32 s61, s37, 0
    s_mov_b32 s62, 0x20000
    s_mov_b32 s63, 0x00020000
    v_lshlrev_b32 v30, 8, v2
    v_lshlrev_b32 v8, 4, v3
    v_add_u32 v30, v30, v8
    v_lshlrev_b32 v31, 10, v3
    v_lshlrev_b32 v8, 4, v2
    v_add_u32 v31, v31, v8
    s_and_b32 s67, s64, 3
    s_lshr_b32 s68, s64, 2
    v_lshlrev_b32 v29, 14, v3
    v_lshlrev_b32 v10, 4, v2
    v_add_u32 v29, v29, v10
    s_lshl_b32 s88, s68, 16
    s_lshl_b32 s69, s67, 8
    s_add_u32 s88, s88, s69
    s_add_u32 s89, s88, 4096
    s_add_u32 s90, s88, 8192
    s_add_u32 s91, s88, 12288
    v_lshrrev_b32 v8, 3, v2
    v_lshlrev_b32 v8, 10, v8
    v_lshlrev_b32 v9, 5, v3
    v_add_u32 v8, v8, v9
    s_lshl_b32 s66, s64, 7
    v_add_u32 v8, s66, v8
    buffer_load_dwordx4 v[12:15], v8, s[52:55], 0 offen
    buffer_load_dwordx4 v[16:19], v8, s[52:55], 0 offen offset:16
    v_lshlrev_b32 v9, 17, v3
    v_lshlrev_b32 v10, 4, v2
    v_add_u32 v9, v9, v10
    s_lshl_b32 s66, s64, 19
    buffer_load_dwordx4 v[160:163], v9, s[56:59], s66 offen
    s_add_u32 s66, s66, 8192
    buffer_load_dwordx4 v[164:167], v9, s[56:59], s66 offen
    s_add_u32 s66, s66, 8192
    buffer_load_dwordx4 v[168:171], v9, s[56:59], s66 offen
    s_add_u32 s66, s66, 8192
    buffer_load_dwordx4 v[172:175], v9, s[56:59], s66 offen
    s_add_u32 s66, s66, 8192
    buffer_load_dwordx4 v[176:179], v9, s[56:59], s66 offen
    s_add_u32 s66, s66, 8192
    buffer_load_dwordx4 v[180:183], v9, s[56:59], s66 offen
    s_add_u32 s66, s66, 8192
    buffer_load_dwordx4 v[184:187], v9, s[56:59], s66 offen
    s_add_u32 s66, s66, 8192
    buffer_load_dwordx4 v[188:191], v9, s[56:59], s66 offen
    s_add_u32 s66, s66, 8192
    buffer_load_dwordx4 v[192:195], v9, s[56:59], s66 offen
    s_add_u32 s66, s66, 8192
    buffer_load_dwordx4 v[196:199], v9, s[56:59], s66 offen
    s_add_u32 s66, s66, 8192
    buffer_load_dwordx4 v[200:203], v9, s[56:59], s66 offen
    s_add_u32 s66, s66, 8192
    buffer_load_dwordx4 v[204:207], v9, s[56:59], s66 offen
    s_add_u32 s66, s66, 8192
    buffer_load_dwordx4 v[208:211], v9, s[56:59], s66 offen
    s_add_u32 s66, s66, 8192
    buffer_load_dwordx4 v[212:215], v9, s[56:59], s66 offen
    s_add_u32 s66, s66, 8192
    buffer_load_dwordx4 v[216:219], v9, s[56:59], s66 offen
    s_add_u32 s66, s66, 8192
    buffer_load_dwordx4 v[220:223], v9, s[56:59], s66 offen
    s_mov_b32 s75, 0
    buffer_load_dwordx4 v[64:67], v31, s[44:47], s75 offen offset:0 nt
    buffer_load_dwordx4 v[68:71], v31, s[44:47], s75 offen offset:256 nt
    buffer_load_dwordx4 v[72:75], v31, s[44:47], s75 offen offset:512 nt
    buffer_load_dwordx4 v[76:79], v31, s[44:47], s75 offen offset:768 nt
    buffer_load_dwordx4 v[80:83], v31, s[48:51], s75 offen offset:0 nt
    buffer_load_dwordx4 v[84:87], v31, s[48:51], s75 offen offset:256 nt
    buffer_load_dwordx4 v[88:91], v31, s[48:51], s75 offen offset:512 nt
    buffer_load_dwordx4 v[92:95], v31, s[48:51], s75 offen offset:768 nt
    s_add_u32 s75, s75, 32768
    buffer_load_dwordx4 v[96:99], v31, s[44:47], s75 offen offset:0 nt
    buffer_load_dwordx4 v[100:103], v31, s[44:47], s75 offen offset:256 nt
    buffer_load_dwordx4 v[104:107], v31, s[44:47], s75 offen offset:512 nt
    buffer_load_dwordx4 v[108:111], v31, s[44:47], s75 offen offset:768 nt
    buffer_load_dwordx4 v[112:115], v31, s[48:51], s75 offen offset:0 nt
    buffer_load_dwordx4 v[116:119], v31, s[48:51], s75 offen offset:256 nt
    buffer_load_dwordx4 v[120:123], v31, s[48:51], s75 offen offset:512 nt
    buffer_load_dwordx4 v[124:127], v31, s[48:51], s75 offen offset:768 nt
    s_add_u32 s75, s75, 32768
    buffer_load_dwordx4 v[128:131], v31, s[44:47], s75 offen offset:0 nt
    buffer_load_dwordx4 v[132:135], v31, s[44:47], s75 offen offset:256 nt
    buffer_load_dwordx4 v[136:139], v31, s[44:47], s75 offen offset:512 nt
    buffer_load_dwordx4 v[140:143], v31, s[44:47], s75 offen offset:768 nt
    buffer_load_dwordx4 v[144:147], v31, s[48:51], s75 offen offset:0 nt
    buffer_load_dwordx4 v[148:151], v31, s[48:51], s75 offen offset:256 nt
    buffer_load_dwordx4 v[152:155], v31, s[48:51], s75 offen offset:512 nt
    buffer_load_dwordx4 v[156:159], v31, s[48:51], s75 offen offset:768 nt
    s_add_u32 s75, s75, 32768
    s_waitcnt vmcnt(39)
    v_perm_b32 v28, v12, v12, s80
    v_and_b32 v24, v28, v4
    v_and_b32 v25, v28, v5
    v_and_b32 v26, v28, v6
    v_and_b32 v27, v28, v7
    s_nop 1
    v_mfma_f32_16x16x32_bf16 v[20:23], v[24:27], v[160:163], 0
    s_waitcnt vmcnt(38)
    v_perm_b32 v28, v12, v12, s81
    v_and_b32 v24, v28, v4
    v_and_b32 v25, v28, v5
    v_and_b32 v26, v28, v6
    v_and_b32 v27, v28, v7
    s_nop 1
    v_mfma_f32_16x16x32_bf16 v[20:23], v[24:27], v[164:167], v[20:23]
    s_waitcnt vmcnt(37)
    v_perm_b32 v28, v13, v13, s80
    v_and_b32 v24, v28, v4
    v_and_b32 v25, v28, v5
    v_and_b32 v26, v28, v6
    v_and_b32 v27, v28, v7
    s_nop 1
    v_mfma_f32_16x16x32_bf16 v[20:23], v[24:27], v[168:171], v[20:23]
    s_waitcnt vmcnt(36)
    v_perm_b32 v28, v13, v13, s81
    v_and_b32 v24, v28, v4
    v_and_b32 v25, v28, v5
    v_and_b32 v26, v28, v6
    v_and_b32 v27, v28, v7
    s_nop 1
    v_mfma_f32_16x16x32_bf16 v[20:23], v[24:27], v[172:175], v[20:23]
    s_waitcnt vmcnt(35)
    v_perm_b32 v28, v14, v14, s80
    v_and_b32 v24, v28, v4
    v_and_b32 v25, v28, v5
    v_and_b32 v26, v28, v6
    v_and_b32 v27, v28, v7
    s_nop 1
    v_mfma_f32_16x16x32_bf16 v[20:23], v[24:27], v[176:179], v[20:23]
    s_waitcnt vmcnt(34)
    v_perm_b32 v28, v14, v14, s81
    v_and_b32 v24, v28, v4
    v_and_b32 v25, v28, v5
    v_and_b32 v26, v28, v6
    v_and_b32 v27, v28, v7
    s_nop 1
    v_mfma_f32_16x16x32_bf16 v[20:23], v[24:27], v[180:183], v[20:23]
    s_waitcnt vmcnt(33)
    v_perm_b32 v28, v15, v15, s80
    v_and_b32 v24, v28, v4
    v_and_b32 v25, v28, v5
    v_and_b32 v26, v28, v6
    v_and_b32 v27, v28, v7
    s_nop 1
    v_mfma_f32_16x16x32_bf16 v[20:23], v[24:27], v[184:187], v[20:23]
    s_waitcnt vmcnt(32)
    v_perm_b32 v28, v15, v15, s81
    v_and_b32 v24, v28, v4
    v_and_b32 v25, v28, v5
    v_and_b32 v26, v28, v6
    v_and_b32 v27, v28, v7
    s_nop 1
    v_mfma_f32_16x16x32_bf16 v[20:23], v[24:27], v[188:191], v[20:23]
    s_waitcnt vmcnt(31)
    v_perm_b32 v28, v16, v16, s80
    v_and_b32 v24, v28, v4
    v_and_b32 v25, v28, v5
    v_and_b32 v26, v28, v6
    v_and_b32 v27, v28, v7
    s_nop 1
    v_mfma_f32_16x16x32_bf16 v[20:23], v[24:27], v[192:195], v[20:23]
    s_waitcnt vmcnt(30)
    v_perm_b32 v28, v16, v16, s81
    v_and_b32 v24, v28, v4
    v_and_b32 v25, v28, v5
    v_and_b32 v26, v28, v6
    v_and_b32 v27, v28, v7
    s_nop 1
    v_mfma_f32_16x16x32_bf16 v[20:23], v[24:27], v[196:199], v[20:23]
    s_waitcnt vmcnt(29)
    v_perm_b32 v28, v17, v17, s80
    v_and_b32 v24, v28, v4
    v_and_b32 v25, v28, v5
    v_and_b32 v26, v28, v6
    v_and_b32 v27, v28, v7
    s_nop 1
    v_mfma_f32_16x16x32_bf16 v[20:23], v[24:27], v[200:203], v[20:23]
    s_waitcnt vmcnt(28)
    v_perm_b32 v28, v17, v17, s81
    v_and_b32 v24, v28, v4
    v_and_b32 v25, v28, v5
    v_and_b32 v26, v28, v6
    v_and_b32 v27, v28, v7
    s_nop 1
    v_mfma_f32_16x16x32_bf16 v[20:23], v[24:27], v[204:207], v[20:23]
    s_waitcnt vmcnt(27)
    v_perm_b32 v28, v18, v18, s80
    v_and_b32 v24, v28, v4
    v_and_b32 v25, v28, v5
    v_and_b32 v26, v28, v6
    v_and_b32 v27, v28, v7
    s_nop 1
    v_mfma_f32_16x16x32_bf16 v[20:23], v[24:27], v[208:211], v[20:23]
    s_waitcnt vmcnt(26)
    v_perm_b32 v28, v18, v18, s81
    v_and_b32 v24, v28, v4
    v_and_b32 v25, v28, v5
    v_and_b32 v26, v28, v6
    v_and_b32 v27, v28, v7
    s_nop 1
    v_mfma_f32_16x16x32_bf16 v[20:23], v[24:27], v[212:215], v[20:23]
    s_waitcnt vmcnt(25)
    v_perm_b32 v28, v19, v19, s80
    v_and_b32 v24, v28, v4
    v_and_b32 v25, v28, v5
    v_and_b32 v26, v28, v6
    v_and_b32 v27, v28, v7
    s_nop 1
    v_mfma_f32_16x16x32_bf16 v[20:23], v[24:27], v[216:219], v[20:23]
    s_waitcnt vmcnt(24)
    v_perm_b32 v28, v19, v19, s81
    v_and_b32 v24, v28, v4
    v_and_b32 v25, v28, v5
    v_and_b32 v26, v28, v6
    v_and_b32 v27, v28, v7
    s_nop 1
    v_mfma_f32_16x16x32_bf16 v[20:23], v[24:27], v[220:223], v[20:23]
    v_lshrrev_b32 v8, 1, v3
    v_lshlrev_b32 v8, 9, v8
    v_lshlrev_b32 v9, 5, v2
    v_add_u32 v8, v8, v9
    v_and_b32 v9, 1, v3
    v_lshlrev_b32 v9, 4, v9
    v_add_u32 v8, v8, v9
    s_lshl_b32 s66, s64, 10
    v_add_u32 v8, s66, v8
    s_nop 7
    ds_write_b128 v8, v[20:23] offset:0
    s_waitcnt lgkmcnt(0)
    s_barrier
    v_and_b32 v8, 255, v0
    v_lshlrev_b32 v9, 2, v8
    ds_read_b32 v12, v9 offset:0
    ds_read_b32 v13, v9 offset:1024
    ds_read_b32 v14, v9 offset:2048
    ds_read_b32 v15, v9 offset:3072
    ds_read_b32 v16, v9 offset:4096
    ds_read_b32 v17, v9 offset:5120
    ds_read_b32 v18, v9 offset:6144
    ds_read_b32 v19, v9 offset:7168
    s_waitcnt lgkmcnt(0)
    v_add_f32 v12, v12, v13
    v_add_f32 v12, v12, v14
    v_add_f32 v12, v12, v15
    v_add_f32 v12, v12, v16
    v_add_f32 v12, v12, v17
    v_add_f32 v12, v12, v18
    v_add_f32 v12, v12, v19
    v_cvt_pk_bf16_f32 v12, v12, v12
    v_lshlrev_b32 v9, 1, v8
    ds_write_b16 v9, v12 offset:10240
    s_waitcnt lgkmcnt(0)
    s_barrier
    buffer_load_dwordx4 v[160:163], v29, s[60:63], s88 offen offset:0
    buffer_load_dwordx4 v[164:167], v29, s[60:63], s88 offen offset:1024
    buffer_load_dwordx4 v[168:171], v29, s[60:63], s88 offen offset:2048
    buffer_load_dwordx4 v[172:175], v29, s[60:63], s88 offen offset:3072
    buffer_load_dwordx4 v[176:179], v29, s[60:63], s89 offen offset:0
    buffer_load_dwordx4 v[180:183], v29, s[60:63], s89 offen offset:1024
    buffer_load_dwordx4 v[184:187], v29, s[60:63], s89 offen offset:2048
    buffer_load_dwordx4 v[188:191], v29, s[60:63], s89 offen offset:3072
    buffer_load_dwordx4 v[192:195], v29, s[60:63], s90 offen offset:0
    buffer_load_dwordx4 v[196:199], v29, s[60:63], s90 offen offset:1024
    buffer_load_dwordx4 v[200:203], v29, s[60:63], s90 offen offset:2048
    buffer_load_dwordx4 v[204:207], v29, s[60:63], s90 offen offset:3072
    buffer_load_dwordx4 v[208:211], v29, s[60:63], s91 offen offset:0
    buffer_load_dwordx4 v[212:215], v29, s[60:63], s91 offen offset:1024
    buffer_load_dwordx4 v[216:219], v29, s[60:63], s91 offen offset:2048
    buffer_load_dwordx4 v[220:223], v29, s[60:63], s91 offen offset:3072
    v_lshlrev_b32 v8, 4, v2
    s_lshl_b32 s66, s73, 8
    v_add_u32 v8, s66, v8
    ds_read_b128 v[32:35], v8 offset:10240
    v_mov_b32 v24, 0
    v_mov_b32 v26, 0xff800000
    v_mov_b32 v27, 0
    v_mov_b32 v16, 0
    v_mov_b32 v17, 0
    v_mov_b32 v18, 0
    v_mov_b32 v19, 0
    s_waitcnt lgkmcnt(0)
L_bloop_1:
    s_waitcnt vmcnt(20)
    v_dot2_f32_bf16 v12, v64, v32, 0
    v_dot2_f32_bf16 v13, v68, v32, 0
    v_dot2_f32_bf16 v14, v72, v32, 0
    v_dot2_f32_bf16 v15, v76, v32, 0
    v_dot2_f32_bf16 v12, v65, v33, v12
    v_dot2_f32_bf16 v13, v69, v33, v13
    v_dot2_f32_bf16 v14, v73, v33, v14
    v_dot2_f32_bf16 v15, v77, v33, v15
    v_dot2_f32_bf16 v12, v66, v34, v12
    v_dot2_f32_bf16 v13, v70, v34, v13
    v_dot2_f32_bf16 v14, v74, v34, v14
    v_dot2_f32_bf16 v15, v78, v34, v15
    v_dot2_f32_bf16 v12, v67, v35, v12
    v_dot2_f32_bf16 v13, v71, v35, v13
    v_dot2_f32_bf16 v14, v75, v35, v14
    v_dot2_f32_bf16 v15, v79, v35, v15
    buffer_load_dwordx4 v[64:67], v31, s[44:47], s75 offen offset:0 nt
    buffer_load_dwordx4 v[68:71], v31, s[44:47], s75 offen offset:256 nt
    buffer_load_dwordx4 v[72:75], v31, s[44:47], s75 offen offset:512 nt
    buffer_load_dwordx4 v[76:79], v31, s[44:47], s75 offen offset:768 nt
    v_add_f32_dpp v12, v12, v12 row_ror:8 row_mask:0xf bank_mask:0xf
    v_add_f32_dpp v13, v13, v13 row_ror:8 row_mask:0xf bank_mask:0xf
    v_add_f32_dpp v14, v14, v14 row_ror:8 row_mask:0xf bank_mask:0xf
    v_add_f32_dpp v15, v15, v15 row_ror:8 row_mask:0xf bank_mask:0xf
    v_add_f32_dpp v12, v12, v12 row_ror:4 row_mask:0xf bank_mask:0xf
    v_add_f32_dpp v13, v13, v13 row_ror:4 row_mask:0xf bank_mask:0xf
    v_add_f32_dpp v14, v14, v14 row_ror:4 row_mask:0xf bank_mask:0xf
    v_add_f32_dpp v15, v15, v15 row_ror:4 row_mask:0xf bank_mask:0xf
    v_add_f32_dpp v12, v12, v12 row_ror:2 row_mask:0xf bank_mask:0xf
    v_add_f32_dpp v13, v13, v13 row_ror:2 row_mask:0xf bank_mask:0xf
    v_add_f32_dpp v14, v14, v14 row_ror:2 row_mask:0xf bank_mask:0xf
    v_add_f32_dpp v15, v15, v15 row_ror:2 row_mask:0xf bank_mask:0xf
    v_add_f32_dpp v12, v12, v12 row_ror:1 row_mask:0xf bank_mask:0xf
    v_add_f32_dpp v13, v13, v13 row_ror:1 row_mask:0xf bank_mask:0xf
    v_add_f32_dpp v14, v14, v14 row_ror:1 row_mask:0xf bank_mask:0xf
    v_add_f32_dpp v15, v15, v15 row_ror:1 row_mask:0xf bank_mask:0xf
    v_max3_f32 v25, v12, v13, v14
    v_max_f32 v25, v25, v15
    v_cmp_gt_f32 vcc, v25, v26
    s_cbranch_vccnz L_brare_3
L_bback_4:
    v_fma_f32 v12, v12, s65, v27
    v_fma_f32 v13, v13, s65, v27
    v_fma_f32 v14, v14, s65, v27
    v_fma_f32 v15, v15, s65, v27
    v_exp_f32 v12, v12
    v_exp_f32 v13, v13
    v_exp_f32 v14, v14
    v_exp_f32 v15, v15
    s_nop 0
    v_cvt_pk_bf16_f32 v20, v12, v12
    v_cvt_pk_bf16_f32 v21, v13, v13
    v_cvt_pk_bf16_f32 v22, v14, v14
    v_cvt_pk_bf16_f32 v23, v15, v15
    v_add_f32 v12, v12, v13
    v_add_f32 v14, v14, v15
    v_add_f32 v24, v24, v12
    v_add_f32 v24, v24, v14
    v_and_b32 v48, v20, v4
    v_and_b32 v49, v20, v5
    v_and_b32 v50, v20, v6
    v_and_b32 v51, v20, v7
    v_and_b32 v52, v21, v4
    v_and_b32 v53, v21, v5
    v_and_b32 v54, v21, v6
    v_and_b32 v55, v21, v7
    v_and_b32 v56, v22, v4
    v_and_b32 v57, v22, v5
    v_and_b32 v58, v22, v6
    v_and_b32 v59, v22, v7
    v_and_b32 v60, v23, v4
    v_and_b32 v61, v23, v5
    v_and_b32 v62, v23, v6
    v_and_b32 v63, v23, v7
    s_waitcnt vmcnt(20)
    v_mfma_f32_16x16x32_bf16 v[16:19], v[48:51], v[80:83], v[16:19]
    v_mfma_f32_16x16x32_bf16 v[16:19], v[52:55], v[84:87], v[16:19]
    v_mfma_f32_16x16x32_bf16 v[16:19], v[56:59], v[88:91], v[16:19]
    v_mfma_f32_16x16x32_bf16 v[16:19], v[60:63], v[92:95], v[16:19]
    buffer_load_dwordx4 v[80:83], v31, s[48:51], s75 offen offset:0 nt
    buffer_load_dwordx4 v[84:87], v31, s[48:51], s75 offen offset:256 nt
    buffer_load_dwordx4 v[88:91], v31, s[48:51], s75 offen offset:512 nt
    buffer_load_dwordx4 v[92:95], v31, s[48:51], s75 offen offset:768 nt
    s_add_u32 s75, s75, 32768
    s_sub_u32 s77, s77, 1
    s_cmp_eq_u32 s77, 0
    s_cbranch_scc1 L_bdone_2
    s_waitcnt vmcnt(20)
    v_dot2_f32_bf16 v12, v96, v32, 0
    v_dot2_f32_bf16 v13, v100, v32, 0
    v_dot2_f32_bf16 v14, v104, v32, 0
    v_dot2_f32_bf16 v15, v108, v32, 0
    v_dot2_f32_bf16 v12, v97, v33, v12
    v_dot2_f32_bf16 v13, v101, v33, v13
    v_dot2_f32_bf16 v14, v105, v33, v14
    v_dot2_f32_bf16 v15, v109, v33, v15
    v_dot2_f32_bf16 v12, v98, v34, v12
    v_dot2_f32_bf16 v13, v102, v34, v13
    v_dot2_f32_bf16 v14, v106, v34, v14
    v_dot2_f32_bf16 v15, v110, v34, v15
    v_dot2_f32_bf16 v12, v99, v35, v12
    v_dot2_f32_bf16 v13, v103, v35, v13
    v_dot2_f32_bf16 v14, v107, v35, v14
    v_dot2_f32_bf16 v15, v111, v35, v15
    buffer_load_dwordx4 v[96:99], v31, s[44:47], s75 offen offset:0 nt
    buffer_load_dwordx4 v[100:103], v31, s[44:47], s75 offen offset:256 nt
    buffer_load_dwordx4 v[104:107], v31, s[44:47], s75 offen offset:512 nt
    buffer_load_dwordx4 v[108:111], v31, s[44:47], s75 offen offset:768 nt
    v_add_f32_dpp v12, v12, v12 row_ror:8 row_mask:0xf bank_mask:0xf
    v_add_f32_dpp v13, v13, v13 row_ror:8 row_mask:0xf bank_mask:0xf
    v_add_f32_dpp v14, v14, v14 row_ror:8 row_mask:0xf bank_mask:0xf
    v_add_f32_dpp v15, v15, v15 row_ror:8 row_mask:0xf bank_mask:0xf
    v_add_f32_dpp v12, v12, v12 row_ror:4 row_mask:0xf bank_mask:0xf
    v_add_f32_dpp v13, v13, v13 row_ror:4 row_mask:0xf bank_mask:0xf
    v_add_f32_dpp v14, v14, v14 row_ror:4 row_mask:0xf bank_mask:0xf
    v_add_f32_dpp v15, v15, v15 row_ror:4 row_mask:0xf bank_mask:0xf
    v_add_f32_dpp v12, v12, v12 row_ror:2 row_mask:0xf bank_mask:0xf
    v_add_f32_dpp v13, v13, v13 row_ror:2 row_mask:0xf bank_mask:0xf
    v_add_f32_dpp v14, v14, v14 row_ror:2 row_mask:0xf bank_mask:0xf
    v_add_f32_dpp v15, v15, v15 row_ror:2 row_mask:0xf bank_mask:0xf
    v_add_f32_dpp v12, v12, v12 row_ror:1 row_mask:0xf bank_mask:0xf
    v_add_f32_dpp v13, v13, v13 row_ror:1 row_mask:0xf bank_mask:0xf
    v_add_f32_dpp v14, v14, v14 row_ror:1 row_mask:0xf bank_mask:0xf
    v_add_f32_dpp v15, v15, v15 row_ror:1 row_mask:0xf bank_mask:0xf
    v_max3_f32 v25, v12, v13, v14
    v_max_f32 v25, v25, v15
    v_cmp_gt_f32 vcc, v25, v26
    s_cbranch_vccnz L_brare_5
L_bback_6:
    v_fma_f32 v12, v12, s65, v27
    v_fma_f32 v13, v13, s65, v27
    v_fma_f32 v14, v14, s65, v27
    v_fma_f32 v15, v15, s65, v27
    v_exp_f32 v12, v12
    v_exp_f32 v13, v13
    v_exp_f32 v14, v14
    v_exp_f32 v15, v15
    s_nop 0
    v_cvt_pk_bf16_f32 v20, v12, v12
    v_cvt_pk_bf16_f32 v21, v13, v13
    v_cvt_pk_bf16_f32 v22, v14, v14
    v_cvt_pk_bf16_f32 v23, v15, v15
    v_add_f32 v12, v12, v13
    v_add_f32 v14, v14, v15
    v_add_f32 v24, v24, v12
    v_add_f32 v24, v24, v14
    v_and_b32 v48, v20, v4
    v_and_b32 v49, v20, v5
    v_and_b32 v50, v20, v6
    v_and_b32 v51, v20, v7
    v_and_b32 v52, v21, v4
    v_and_b32 v53, v21, v5
    v_and_b32 v54, v21, v6
    v_and_b32 v55, v21, v7
    v_and_b32 v56, v22, v4
    v_and_b32 v57, v22, v5
    v_and_b32 v58, v22, v6
    v_and_b32 v59, v22, v7
    v_and_b32 v60, v23, v4
    v_and_b32 v61, v23, v5
    v_and_b32 v62, v23, v6
    v_and_b32 v63, v23, v7
    s_waitcnt vmcnt(20)
    v_mfma_f32_16x16x32_bf16 v[16:19], v[48:51], v[112:115], v[16:19]
    v_mfma_f32_16x16x32_bf16 v[16:19], v[52:55], v[116:119], v[16:19]
    v_mfma_f32_16x16x32_bf16 v[16:19], v[56:59], v[120:123], v[16:19]
    v_mfma_f32_16x16x32_bf16 v[16:19], v[60:63], v[124:127], v[16:19]
    buffer_load_dwordx4 v[112:115], v31, s[48:51], s75 offen offset:0 nt
    buffer_load_dwordx4 v[116:119], v31, s[48:51], s75 offen offset:256 nt
    buffer_load_dwordx4 v[120:123], v31, s[48:51], s75 offen offset:512 nt
    buffer_load_dwordx4 v[124:127], v31, s[48:51], s75 offen offset:768 nt
    s_add_u32 s75, s75, 32768
    s_sub_u32 s77, s77, 1
    s_cmp_eq_u32 s77, 0
    s_cbranch_scc1 L_bdone_2
    s_waitcnt vmcnt(20)
    v_dot2_f32_bf16 v12, v128, v32, 0
    v_dot2_f32_bf16 v13, v132, v32, 0
    v_dot2_f32_bf16 v14, v136, v32, 0
    v_dot2_f32_bf16 v15, v140, v32, 0
    v_dot2_f32_bf16 v12, v129, v33, v12
    v_dot2_f32_bf16 v13, v133, v33, v13
    v_dot2_f32_bf16 v14, v137, v33, v14
    v_dot2_f32_bf16 v15, v141, v33, v15
    v_dot2_f32_bf16 v12, v130, v34, v12
    v_dot2_f32_bf16 v13, v134, v34, v13
    v_dot2_f32_bf16 v14, v138, v34, v14
    v_dot2_f32_bf16 v15, v142, v34, v15
    v_dot2_f32_bf16 v12, v131, v35, v12
    v_dot2_f32_bf16 v13, v135, v35, v13
    v_dot2_f32_bf16 v14, v139, v35, v14
    v_dot2_f32_bf16 v15, v143, v35, v15
    buffer_load_dwordx4 v[128:131], v31, s[44:47], s75 offen offset:0 nt
    buffer_load_dwordx4 v[132:135], v31, s[44:47], s75 offen offset:256 nt
    buffer_load_dwordx4 v[136:139], v31, s[44:47], s75 offen offset:512 nt
    buffer_load_dwordx4 v[140:143], v31, s[44:47], s75 offen offset:768 nt
    v_add_f32_dpp v12, v12, v12 row_ror:8 row_mask:0xf bank_mask:0xf
    v_add_f32_dpp v13, v13, v13 row_ror:8 row_mask:0xf bank_mask:0xf
    v_add_f32_dpp v14, v14, v14 row_ror:8 row_mask:0xf bank_mask:0xf
    v_add_f32_dpp v15, v15, v15 row_ror:8 row_mask:0xf bank_mask:0xf
    v_add_f32_dpp v12, v12, v12 row_ror:4 row_mask:0xf bank_mask:0xf
    v_add_f32_dpp v13, v13, v13 row_ror:4 row_mask:0xf bank_mask:0xf
    v_add_f32_dpp v14, v14, v14 row_ror:4 row_mask:0xf bank_mask:0xf
    v_add_f32_dpp v15, v15, v15 row_ror:4 row_mask:0xf bank_mask:0xf
    v_add_f32_dpp v12, v12, v12 row_ror:2 row_mask:0xf bank_mask:0xf
    v_add_f32_dpp v13, v13, v13 row_ror:2 row_mask:0xf bank_mask:0xf
    v_add_f32_dpp v14, v14, v14 row_ror:2 row_mask:0xf bank_mask:0xf
    v_add_f32_dpp v15, v15, v15 row_ror:2 row_mask:0xf bank_mask:0xf
    v_add_f32_dpp v12, v12, v12 row_ror:1 row_mask:0xf bank_mask:0xf
    v_add_f32_dpp v13, v13, v13 row_ror:1 row_mask:0xf bank_mask:0xf
    v_add_f32_dpp v14, v14, v14 row_ror:1 row_mask:0xf bank_mask:0xf
    v_add_f32_dpp v15, v15, v15 row_ror:1 row_mask:0xf bank_mask:0xf
    v_max3_f32 v25, v12, v13, v14
    v_max_f32 v25, v25, v15
    v_cmp_gt_f32 vcc, v25, v26
    s_cbranch_vccnz L_brare_7
L_bback_8:
    v_fma_f32 v12, v12, s65, v27
    v_fma_f32 v13, v13, s65, v27
    v_fma_f32 v14, v14, s65, v27
    v_fma_f32 v15, v15, s65, v27
    v_exp_f32 v12, v12
    v_exp_f32 v13, v13
    v_exp_f32 v14, v14
    v_exp_f32 v15, v15
    s_nop 0
    v_cvt_pk_bf16_f32 v20, v12, v12
    v_cvt_pk_bf16_f32 v21, v13, v13
    v_cvt_pk_bf16_f32 v22, v14, v14
    v_cvt_pk_bf16_f32 v23, v15, v15
    v_add_f32 v12, v12, v13
    v_add_f32 v14, v14, v15
    v_add_f32 v24, v24, v12
    v_add_f32 v24, v24, v14
    v_and_b32 v48, v20, v4
    v_and_b32 v49, v20, v5
    v_and_b32 v50, v20, v6
    v_and_b32 v51, v20, v7
    v_and_b32 v52, v21, v4
    v_and_b32 v53, v21, v5
    v_and_b32 v54, v21, v6
    v_and_b32 v55, v21, v7
    v_and_b32 v56, v22, v4
    v_and_b32 v57, v22, v5
    v_and_b32 v58, v22, v6
    v_and_b32 v59, v22, v7
    v_and_b32 v60, v23, v4
    v_and_b32 v61, v23, v5
    v_and_b32 v62, v23, v6
    v_and_b32 v63, v23, v7
    s_waitcnt vmcnt(20)
    v_mfma_f32_16x16x32_bf16 v[16:19], v[48:51], v[144:147], v[16:19]
    v_mfma_f32_16x16x32_bf16 v[16:19], v[52:55], v[148:151], v[16:19]
    v_mfma_f32_16x16x32_bf16 v[16:19], v[56:59], v[152:155], v[16:19]
    v_mfma_f32_16x16x32_bf16 v[16:19], v[60:63], v[156:159], v[16:19]
    buffer_load_dwordx4 v[144:147], v31, s[48:51], s75 offen offset:0 nt
    buffer_load_dwordx4 v[148:151], v31, s[48:51], s75 offen offset:256 nt
    buffer_load_dwordx4 v[152:155], v31, s[48:51], s75 offen offset:512 nt
    buffer_load_dwordx4 v[156:159], v31, s[48:51], s75 offen offset:768 nt
    s_add_u32 s75, s75, 32768
    s_sub_u32 s77, s77, 1
    s_cmp_eq_u32 s77, 0
    s_cbranch_scc0 L_bloop_1
    s_branch L_bdone_2
L_brare_3:
    v_readlane_b32 s82, v25, 0
    v_readlane_b32 s83, v25, 16
    v_readlane_b32 s70, v25, 32
    v_readlane_b32 s71, v25, 48
    s_nop 1
    v_max_f32 v25, s82, v26
    v_max_f32 v25, s83, v25
    v_max_f32 v25, s70, v25
    v_max_f32 v25, s71, v25
    v_sub_f32 v8, v26, v25
    v_mul_f32 v8, s65, v8
    v_exp_f32 v8, v8
    v_mov_b32 v26, v25
    v_mul_f32 v27, s65, v25
    v_sub_f32 v27, 0, v27
    v_mul_f32 v24, v24, v8
    v_mul_f32 v16, v16, v8
    v_mul_f32 v17, v17, v8
    v_mul_f32 v18, v18, v8
    v_mul_f32 v19, v19, v8
    s_branch L_bback_4
L_brare_5:
    v_readlane_b32 s82, v25, 0
    v_readlane_b32 s83, v25, 16
    v_readlane_b32 s70, v25, 32
    v_readlane_b32 s71, v25, 48
    s_nop 1
    v_max_f32 v25, s82, v26
    v_max_f32 v25, s83, v25
    v_max_f32 v25, s70, v25
    v_max_f32 v25, s71, v25
    v_sub_f32 v8, v26, v25
    v_mul_f32 v8, s65, v8
    v_exp_f32 v8, v8
    v_mov_b32 v26, v25
    v_mul_f32 v27, s65, v25
    v_sub_f32 v27, 0, v27
    v_mul_f32 v24, v24, v8
    v_mul_f32 v16, v16, v8
    v_mul_f32 v17, v17, v8
    v_mul_f32 v18, v18, v8
    v_mul_f32 v19, v19, v8
    s_branch L_bback_6
L_brare_7:
    v_readlane_b32 s82, v25, 0
    v_readlane_b32 s83, v25, 16
    v_readlane_b32 s70, v25, 32
    v_readlane_b32 s71, v25, 48
    s_nop 1
    v_max_f32 v25, s82, v26
    v_max_f32 v25, s83, v25
    v_max_f32 v25, s70, v25
    v_max_f32 v25, s71, v25
    v_sub_f32 v8, v26, v25
    v_mul_f32 v8, s65, v8
    v_exp_f32 v8, v8
    v_mov_b32 v26, v25
    v_mul_f32 v27, s65, v25
    v_sub_f32 v27, 0, v27
    v_mul_f32 v24, v24, v8
    v_mul_f32 v16, v16, v8
    v_mul_f32 v17, v17, v8
    v_mul_f32 v18, v18, v8
    v_mul_f32 v19, v19, v8
    s_branch L_bback_8
L_bdone_2:
    s_nop 7
    v_readlane_b32 s82, v24, 0
    v_readlane_b32 s83, v24, 16
    v_readlane_b32 s70, v24, 32
    v_readlane_b32 s71, v24, 48
    s_nop 1
    v_mov_b32 v24, s82
    v_add_f32 v24, s83, v24
    v_add_f32 v24, s70, v24
    v_add_f32 v27, s71, v24
    v_lshlrev_b32 v8, 5, v2
    v_lshlrev_b32 v9, 4, v3
    v_add_u32 v8, v8, v9
    s_lshl_b32 s66, s64, 9
    v_add_u32 v8, s66, v8
    s_lshl_b32 s66, s64, 3
    v_mov_b32 v9, s66
    v_cmp_gt_u32 vcc, 32, v1
    s_and_saveexec_b64 s[78:79], vcc
    ds_write_b128 v8, v[16:19] offset:0
    ds_write_b64 v9, v[26:27] offset:11264
    s_mov_b64 exec, s[78:79]
    s_waitcnt lgkmcnt(0)
    s_barrier
    v_mov_b32 v8, 0
    ds_read_b128 v[32:35], v8 offset:11264
    ds_read_b128 v[36:39], v8 offset:11280
    ds_read_b128 v[40:43], v8 offset:11296
    ds_read_b128 v[44:47], v8 offset:11312
    v_and_b32 v9, 127, v0
    v_lshlrev_b32 v10, 2, v9
    ds_read_b32 v48, v10 offset:0
    ds_read_b32 v49, v10 offset:512
    ds_read_b32 v50, v10 offset:1024
    ds_read_b32 v51, v10 offset:1536
    ds_read_b32 v52, v10 offset:2048
    ds_read_b32 v53, v10 offset:2560
    ds_read_b32 v54, v10 offset:3072
    ds_read_b32 v55, v10 offset:3584
    s_waitcnt lgkmcnt(0)
    v_max3_f32 v56, v32, v34, v36
    v_max3_f32 v56, v56, v38, v40
    v_max3_f32 v56, v56, v42, v44
    v_max_f32 v56, v56, v46
    v_sub_f32 v32, v32, v56
    v_mul_f32 v32, s65, v32
    v_exp_f32 v32, v32
    v_sub_f32 v34, v34, v56
    v_mul_f32 v34, s65, v34
    v_exp_f32 v34, v34
    v_sub_f32 v36, v36, v56
    v_mul_f32 v36, s65, v36
    v_exp_f32 v36, v36
    v_sub_f32 v38, v38, v56
    v_mul_f32 v38, s65, v38
    v_exp_f32 v38, v38
    v_sub_f32 v40, v40, v56
    v_mul_f32 v40, s65, v40
    v_exp_f32 v40, v40
    v_sub_f32 v42, v42, v56
    v_mul_f32 v42, s65, v42
    v_exp_f32 v42, v42
    v_sub_f32 v44, v44, v56
    v_mul_f32 v44, s65, v44
    v_exp_f32 v44, v44
    v_sub_f32 v46, v46, v56
    v_mul_f32 v46, s65, v46
    v_exp_f32 v46, v46
    s_nop 0
    v_mul_f32 v57, v32, v33
    v_mul_f32 v58, v32, v48
    v_fmac_f32 v57, v34, v35
    v_fmac_f32 v58, v34, v49
    v_fmac_f32 v57, v36, v37
    v_fmac_f32 v58, v36, v50
    v_fmac_f32 v57, v38, v39
    v_fmac_f32 v58, v38, v51
    v_fmac_f32 v57, v40, v41
    v_fmac_f32 v58, v40, v52
    v_fmac_f32 v57, v42, v43
    v_fmac_f32 v58, v42, v53
    v_fmac_f32 v57, v44, v45
    v_fmac_f32 v58, v44, v54
    v_fmac_f32 v57, v46, v47
    v_fmac_f32 v58, v46, v55
    v_cvt_pk_bf16_f32 v58, v58, v58
    v_lshlrev_b32 v9, 1, v9
    ds_write_b16 v9, v58 offset:8192
    s_waitcnt lgkmcnt(0) vmcnt(0)
    s_barrier
    s_and_b32 s67, s64, 3
    s_lshr_b32 s68, s64, 2
    v_lshlrev_b32 v8, 5, v3
    s_lshl_b32 s66, s68, 7
    v_add_u32 v8, s66, v8
    ds_read_b128 v[12:15], v8 offset:8192
    ds_read_b128 v[16:19], v8 offset:8208
    s_waitcnt lgkmcnt(0)
    v_perm_b32 v28, v12, v12, s80
    v_and_b32 v24, v28, v4
    v_and_b32 v25, v28, v5
    v_and_b32 v26, v28, v6
    v_and_b32 v27, v28, v7
    s_nop 1
    v_mfma_f32_16x16x32_bf16 v[20:23], v[24:27], v[160:163], 0
    v_perm_b32 v28, v12, v12, s81
    v_and_b32 v24, v28, v4
    v_and_b32 v25, v28, v5
    v_and_b32 v26, v28, v6
    v_and_b32 v27, v28, v7
    s_nop 1
    v_mfma_f32_16x16x32_bf16 v[20:23], v[24:27], v[164:167], v[20:23]
    v_perm_b32 v28, v13, v13, s80
    v_and_b32 v24, v28, v4
    v_and_b32 v25, v28, v5
    v_and_b32 v26, v28, v6
    v_and_b32 v27, v28, v7
    s_nop 1
    v_mfma_f32_16x16x32_bf16 v[20:23], v[24:27], v[168:171], v[20:23]
    v_perm_b32 v28, v13, v13, s81
    v_and_b32 v24, v28, v4
    v_and_b32 v25, v28, v5
    v_and_b32 v26, v28, v6
    v_and_b32 v27, v28, v7
    s_nop 1
    v_mfma_f32_16x16x32_bf16 v[20:23], v[24:27], v[172:175], v[20:23]
    v_perm_b32 v28, v14, v14, s80
    v_and_b32 v24, v28, v4
    v_and_b32 v25, v28, v5
    v_and_b32 v26, v28, v6
    v_and_b32 v27, v28, v7
    s_nop 1
    v_mfma_f32_16x16x32_bf16 v[20:23], v[24:27], v[176:179], v[20:23]
    v_perm_b32 v28, v14, v14, s81
    v_and_b32 v24, v28, v4
    v_and_b32 v25, v28, v5
    v_and_b32 v26, v28, v6
    v_and_b32 v27, v28, v7
    s_nop 1
    v_mfma_f32_16x16x32_bf16 v[20:23], v[24:27], v[180:183], v[20:23]
    v_perm_b32 v28, v15, v15, s80
    v_and_b32 v24, v28, v4
    v_and_b32 v25, v28, v5
    v_and_b32 v26, v28, v6
    v_and_b32 v27, v28, v7
    s_nop 1
    v_mfma_f32_16x16x32_bf16 v[20:23], v[24:27], v[184:187], v[20:23]
    v_perm_b32 v28, v15, v15, s81
    v_and_b32 v24, v28, v4
    v_and_b32 v25, v28, v5
    v_and_b32 v26, v28, v6
    v_and_b32 v27, v28, v7
    s_nop 1
    v_mfma_f32_16x16x32_bf16 v[20:23], v[24:27], v[188:191], v[20:23]
    v_perm_b32 v28, v16, v16, s80
    v_and_b32 v24, v28, v4
    v_and_b32 v25, v28, v5
    v_and_b32 v26, v28, v6
    v_and_b32 v27, v28, v7
    s_nop 1
    v_mfma_f32_16x16x32_bf16 v[20:23], v[24:27], v[192:195], v[20:23]
    v_perm_b32 v28, v16, v16, s81
    v_and_b32 v24, v28, v4
    v_and_b32 v25, v28, v5
    v_and_b32 v26, v28, v6
    v_and_b32 v27, v28, v7
    s_nop 1
    v_mfma_f32_16x16x32_bf16 v[20:23], v[24:27], v[196:199], v[20:23]
    v_perm_b32 v28, v17, v17, s80
    v_and_b32 v24, v28, v4
    v_and_b32 v25, v28, v5
    v_and_b32 v26, v28, v6
    v_and_b32 v27, v28, v7
    s_nop 1
    v_mfma_f32_16x16x32_bf16 v[20:23], v[24:27], v[200:203], v[20:23]
    v_perm_b32 v28, v17, v17, s81
    v_and_b32 v24, v28, v4
    v_and_b32 v25, v28, v5
    v_and_b32 v26, v28, v6
    v_and_b32 v27, v28, v7
    s_nop 1
    v_mfma_f32_16x16x32_bf16 v[20:23], v[24:27], v[204:207], v[20:23]
    v_perm_b32 v28, v18, v18, s80
    v_and_b32 v24, v28, v4
    v_and_b32 v25, v28, v5
    v_and_b32 v26, v28, v6
    v_and_b32 v27, v28, v7
    s_nop 1
    v_mfma_f32_16x16x32_bf16 v[20:23], v[24:27], v[208:211], v[20:23]
    v_perm_b32 v28, v18, v18, s81
    v_and_b32 v24, v28, v4
    v_and_b32 v25, v28, v5
    v_and_b32 v26, v28, v6
    v_and_b32 v27, v28, v7
    s_nop 1
    v_mfma_f32_16x16x32_bf16 v[20:23], v[24:27], v[212:215], v[20:23]
    v_perm_b32 v28, v19, v19, s80
    v_and_b32 v24, v28, v4
    v_and_b32 v25, v28, v5
    v_and_b32 v26, v28, v6
    v_and_b32 v27, v28, v7
    s_nop 1
    v_mfma_f32_16x16x32_bf16 v[20:23], v[24:27], v[216:219], v[20:23]
    v_perm_b32 v28, v19, v19, s81
    v_and_b32 v24, v28, v4
    v_and_b32 v25, v28, v5
    v_and_b32 v26, v28, v6
    v_and_b32 v27, v28, v7
    s_nop 1
    v_mfma_f32_16x16x32_bf16 v[20:23], v[24:27], v[220:223], v[20:23]
    v_lshrrev_b32 v8, 1, v3
    v_lshlrev_b32 v8, 11, v8
    v_lshlrev_b32 v9, 5, v2
    v_add_u32 v8, v8, v9
    v_and_b32 v9, 1, v3
    v_lshlrev_b32 v9, 4, v9
    v_add_u32 v8, v8, v9
    s_lshl_b32 s66, s68, 12
    s_lshl_b32 s69, s67, 9
    s_add_u32 s66, s66, s69
    v_add_u32 v8, s66, v8
    s_nop 7
    ds_write_b128 v8, v[20:23] offset:12288
    s_waitcnt lgkmcnt(0)
    s_barrier
    s_lshl_b32 s66, s73, 5
    s_add_u32 s66, s66, s72
    s_lshl_b32 s66, s66, 2
    s_add_u32 s66, s66, s74
    s_lshl_b32 s76, s66, 11
    s_add_u32 s76, s76, 4456448
    s_add_u32 s56, s42, s76
    s_addc_u32 s57, s43, 0
    s_mov_b32 s58, 0x800
    s_mov_b32 s59, 0x00020000
    s_lshl_b32 s76, s66, 3
    s_add_u32 s76, s76, 4980736
    s_add_u32 s60, s42, s76
    s_addc_u32 s61, s43, 0
    s_mov_b32 s62, 0x8
    s_mov_b32 s63, 0x00020000
    v_lshlrev_b32 v8, 2, v0
    ds_read_b32 v9, v8 offset:12288
    ds_read_b32 v10, v8 offset:16384
    s_waitcnt lgkmcnt(0)
    v_add_f32 v9, v9, v10
    buffer_store_dword v9, v8, s[56:59], 0 offen
    v_lshlrev_b32 v8, 3, v0
    buffer_store_dwordx2 v[56:57], v8, s[60:63], 0 offen
    s_endpgm
L_main_A:
    s_mov_b32 s84, s40
    s_mov_b32 s85, s41
    s_mov_b32 s86, 0x100
    s_mov_b32 s87, 0x00020000
    s_and_b32 s72, s2, 31
    s_lshl_b32 s76, s72, 8
    s_mov_b32 s44, s16
    s_mov_b32 s45, s17
    s_mov_b32 s46, 0x800
    s_mov_b32 s47, 0x00020000
    s_add_u32 s48, s20, s76
    s_addc_u32 s49, s21, 0
    s_mov_b32 s50, 0x0
    s_mov_b32 s51, 0x00020000
    s_sub_u32 s50, 4194304, s76
    s_add_u32 s52, s22, s76
    s_addc_u32 s53, s23, 0
    s_mov_b32 s54, 0x0
    s_mov_b32 s55, 0x00020000
    s_sub_u32 s54, 4194304, s76
    s_add_u32 s56, s42, 0x0
    s_addc_u32 s57, s43, 0
    s_mov_b32 s58, 0x10000
    s_mov_b32 s59, 0x00020000
    v_lshrrev_b32 v8, 3, v2
    v_lshlrev_b32 v8, 10, v8
    v_lshlrev_b32 v9, 5, v3
    v_add_u32 v8, v8, v9
    s_lshl_b32 s66, s64, 7
    v_add_u32 v8, s66, v8
    buffer_load_dwordx4 v[12:15], v8, s[44:47], 0 offen
    buffer_load_dwordx4 v[16:19], v8, s[44:47], 0 offen offset:16
    v_lshlrev_b32 v9, 17, v3
    v_lshlrev_b32 v10, 4, v2
    v_add_u32 v9, v9, v10
    s_lshl_b32 s66, s64, 19
    buffer_load_dwordx4 v[160:163], v9, s[48:51], s66 offen
    s_add_u32 s66, s66, 8192
    buffer_load_dwordx4 v[164:167], v9, s[48:51], s66 offen
    s_add_u32 s66, s66, 8192
    buffer_load_dwordx4 v[168:171], v9, s[48:51], s66 offen
    s_add_u32 s66, s66, 8192
    buffer_load_dwordx4 v[172:175], v9, s[48:51], s66 offen
    s_add_u32 s66, s66, 8192
    buffer_load_dwordx4 v[176:179], v9, s[48:51], s66 offen
    s_add_u32 s66, s66, 8192
    buffer_load_dwordx4 v[180:183], v9, s[48:51], s66 offen
    s_add_u32 s66, s66, 8192
    buffer_load_dwordx4 v[184:187], v9, s[48:51], s66 offen
    s_add_u32 s66, s66, 8192
    buffer_load_dwordx4 v[188:191], v9, s[48:51], s66 offen
    s_add_u32 s66, s66, 8192
    buffer_load_dwordx4 v[192:195], v9, s[48:51], s66 offen
    s_add_u32 s66, s66, 8192
    buffer_load_dwordx4 v[196:199], v9, s[48:51], s66 offen
    s_add_u32 s66, s66, 8192
    buffer_load_dwordx4 v[200:203], v9, s[48:51], s66 offen
    s_add_u32 s66, s66, 8192
    buffer_load_dwordx4 v[204:207], v9, s[48:51], s66 offen
    s_add_u32 s66, s66, 8192
    buffer_load_dwordx4 v[208:211], v9, s[48:51], s66 offen
    s_add_u32 s66, s66, 8192
    buffer_load_dwordx4 v[212:215], v9, s[48:51], s66 offen
    s_add_u32 s66, s66, 8192
    buffer_load_dwordx4 v[216:219], v9, s[48:51], s66 offen
    s_add_u32 s66, s66, 8192
    buffer_load_dwordx4 v[220:223], v9, s[48:51], s66 offen
    v_lshlrev_b32 v30, 13, v2
    v_lshlrev_b32 v10, 4, v3
    v_add_u32 v30, v30, v10
    s_lshr_b32 s67, s2, 5
    s_lshl_b32 s67, s67, 21
    s_lshl_b32 s68, s64, 18
    s_add_u32 s67, s67, s68
    s_add_u32 s68, s67, 131072
    buffer_load_dwordx4 v[224:227], v30, s[52:55], s67 offen offset:0
    buffer_load_dwordx4 v[228:231], v30, s[52:55], s67 offen offset:64
    buffer_load_dwordx4 v[232:235], v30, s[52:55], s67 offen offset:128
    buffer_load_dwordx4 v[236:239], v30, s[52:55], s67 offen offset:192
    buffer_load_dwordx4 v[240:243], v30, s[52:55], s68 offen offset:0
    buffer_load_dwordx4 v[244:247], v30, s[52:55], s68 offen offset:64
    buffer_load_dwordx4 v[248:251], v30, s[52:55], s68 offen offset:128
    buffer_load_dwordx4 v[252:255], v30, s[52:55], s68 offen offset:192
    s_waitcnt vmcnt(23)
    v_perm_b32 v28, v12, v12, s80
    v_and_b32 v24, v28, v4
    v_and_b32 v25, v28, v5
    v_and_b32 v26, v28, v6
    v_and_b32 v27, v28, v7
    s_nop 1
    v_mfma_f32_16x16x32_bf16 v[20:23], v[24:27], v[160:163], 0
    s_waitcnt vmcnt(22)
    v_perm_b32 v28, v12, v12, s81
    v_and_b32 v24, v28, v4
    v_and_b32 v25, v28, v5
    v_and_b32 v26, v28, v6
    v_and_b32 v27, v28, v7
    s_nop 1
    v_mfma_f32_16x16x32_bf16 v[20:23], v[24:27], v[164:167], v[20:23]
    s_waitcnt vmcnt(21)
    v_perm_b32 v28, v13, v13, s80
    v_and_b32 v24, v28, v4
    v_and_b32 v25, v28, v5
    v_and_b32 v26, v28, v6
    v_and_b32 v27, v28, v7
    s_nop 1
    v_mfma_f32_16x16x32_bf16 v[20:23], v[24:27], v[168:171], v[20:23]
    s_waitcnt vmcnt(20)
    v_perm_b32 v28, v13, v13, s81
    v_and_b32 v24, v28, v4
    v_and_b32 v25, v28, v5
    v_and_b32 v26, v28, v6
    v_and_b32 v27, v28, v7
    s_nop 1
    v_mfma_f32_16x16x32_bf16 v[20:23], v[24:27], v[172:175], v[20:23]
    s_waitcnt vmcnt(19)
    v_perm_b32 v28, v14, v14, s80
    v_and_b32 v24, v28, v4
    v_and_b32 v25, v28, v5
    v_and_b32 v26, v28, v6
    v_and_b32 v27, v28, v7
    s_nop 1
    v_mfma_f32_16x16x32_bf16 v[20:23], v[24:27], v[176:179], v[20:23]
    s_waitcnt vmcnt(18)
    v_perm_b32 v28, v14, v14, s81
    v_and_b32 v24, v28, v4
    v_and_b32 v25, v28, v5
    v_and_b32 v26, v28, v6
    v_and_b32 v27, v28, v7
    s_nop 1
    v_mfma_f32_16x16x32_bf16 v[20:23], v[24:27], v[180:183], v[20:23]
    s_waitcnt vmcnt(17)
    v_perm_b32 v28, v15, v15, s80
    v_and_b32 v24, v28, v4
    v_and_b32 v25, v28, v5
    v_and_b32 v26, v28, v6
    v_and_b32 v27, v28, v7
    s_nop 1
    v_mfma_f32_16x16x32_bf16 v[20:23], v[24:27], v[184:187], v[20:23]
    s_waitcnt vmcnt(16)
    v_perm_b32 v28, v15, v15, s81
    v_and_b32 v24, v28, v4
    v_and_b32 v25, v28, v5
    v_and_b32 v26, v28, v6
    v_and_b32 v27, v28, v7
    s_nop 1
    v_mfma_f32_16x16x32_bf16 v[20:23], v[24:27], v[188:191], v[20:23]
    s_waitcnt vmcnt(15)
    v_perm_b32 v28, v16, v16, s80
    v_and_b32 v24, v28, v4
    v_and_b32 v25, v28, v5
    v_and_b32 v26, v28, v6
    v_and_b32 v27, v28, v7
    s_nop 1
    v_mfma_f32_16x16x32_bf16 v[20:23], v[24:27], v[192:195], v[20:23]
    s_waitcnt vmcnt(14)
    v_perm_b32 v28, v16, v16, s81
    v_and_b32 v24, v28, v4
    v_and_b32 v25, v28, v5
    v_and_b32 v26, v28, v6
    v_and_b32 v27, v28, v7
    s_nop 1
    v_mfma_f32_16x16x32_bf16 v[20:23], v[24:27], v[196:199], v[20:23]
    s_waitcnt vmcnt(13)
    v_perm_b32 v28, v17, v17, s80
    v_and_b32 v24, v28, v4
    v_and_b32 v25, v28, v5
    v_and_b32 v26, v28, v6
    v_and_b32 v27, v28, v7
    s_nop 1
    v_mfma_f32_16x16x32_bf16 v[20:23], v[24:27], v[200:203], v[20:23]
    s_waitcnt vmcnt(12)
    v_perm_b32 v28, v17, v17, s81
    v_and_b32 v24, v28, v4
    v_and_b32 v25, v28, v5
    v_and_b32 v26, v28, v6
    v_and_b32 v27, v28, v7
    s_nop 1
    v_mfma_f32_16x16x32_bf16 v[20:23], v[24:27], v[204:207], v[20:23]
    s_waitcnt vmcnt(11)
    v_perm_b32 v28, v18, v18, s80
    v_and_b32 v24, v28, v4
    v_and_b32 v25, v28, v5
    v_and_b32 v26, v28, v6
    v_and_b32 v27, v28, v7
    s_nop 1
    v_mfma_f32_16x16x32_bf16 v[20:23], v[24:27], v[208:211], v[20:23]
    s_waitcnt vmcnt(10)
    v_perm_b32 v28, v18, v18, s81
    v_and_b32 v24, v28, v4
    v_and_b32 v25, v28, v5
    v_and_b32 v26, v28, v6
    v_and_b32 v27, v28, v7
    s_nop 1
    v_mfma_f32_16x16x32_bf16 v[20:23], v[24:27], v[212:215], v[20:23]
    s_waitcnt vmcnt(9)
    v_perm_b32 v28, v19, v19, s80
    v_and_b32 v24, v28, v4
    v_and_b32 v25, v28, v5
    v_and_b32 v26, v28, v6
    v_and_b32 v27, v28, v7
    s_nop 1
    v_mfma_f32_16x16x32_bf16 v[20:23], v[24:27], v[216:219], v[20:23]
    s_waitcnt vmcnt(8)
    v_perm_b32 v28, v19, v19, s81
    v_and_b32 v24, v28, v4
    v_and_b32 v25, v28, v5
    v_and_b32 v26, v28, v6
    v_and_b32 v27, v28, v7
    s_nop 1
    v_mfma_f32_16x16x32_bf16 v[20:23], v[24:27], v[220:223], v[20:23]
    v_lshrrev_b32 v8, 1, v3
    v_lshlrev_b32 v8, 9, v8
    v_lshlrev_b32 v9, 5, v2
    v_add_u32 v8, v8, v9
    v_and_b32 v9, 1, v3
    v_lshlrev_b32 v9, 4, v9
    v_add_u32 v8, v8, v9
    s_lshl_b32 s66, s64, 10
    v_add_u32 v8, s66, v8
    s_nop 7
    ds_write_b128 v8, v[20:23] offset:0
    s_waitcnt lgkmcnt(0)
    s_barrier
    v_and_b32 v8, 255, v0
    v_lshlrev_b32 v9, 2, v8
    ds_read_b32 v12, v9 offset:0
    ds_read_b32 v13, v9 offset:1024
    ds_read_b32 v14, v9 offset:2048
    ds_read_b32 v15, v9 offset:3072
    ds_read_b32 v16, v9 offset:4096
    ds_read_b32 v17, v9 offset:5120
    ds_read_b32 v18, v9 offset:6144
    ds_read_b32 v19, v9 offset:7168
    s_waitcnt lgkmcnt(0)
    v_add_f32 v12, v12, v13
    v_add_f32 v12, v12, v14
    v_add_f32 v12, v12, v15
    v_add_f32 v12, v12, v16
    v_add_f32 v12, v12, v17
    v_add_f32 v12, v12, v18
    v_add_f32 v12, v12, v19
    v_cvt_pk_bf16_f32 v12, v12, v12
    v_lshlrev_b32 v9, 1, v8
    ds_write_b16 v9, v12 offset:10240
    s_waitcnt lgkmcnt(0)
    s_barrier
    v_and_b32 v8, 1, v2
    v_lshlrev_b32 v8, 8, v8
    v_lshlrev_b32 v9, 4, v3
    v_add_u32 v8, v8, v9
    ds_read_b128 v[160:163], v8 offset:10240
    ds_read_b128 v[164:167], v8 offset:10304
    ds_read_b128 v[168:171], v8 offset:10368
    ds_read_b128 v[172:175], v8 offset:10432
    v_lshlrev_b32 v8, 15, v2
    v_lshlrev_b32 v10, 3, v3
    v_add_u32 v8, v8, v10
    s_lshl_b32 s66, s72, 10
    s_lshr_b32 s67, s2, 5
    s_lshl_b32 s67, s67, 9
    s_add_u32 s66, s66, s67
    s_lshl_b32 s67, s64, 6
    s_add_u32 s66, s66, s67
    v_add_u32 v8, s66, v8
    s_waitcnt lgkmcnt(0) vmcnt(0)
    v_mfma_f32_16x16x32_bf16 v[176:179], v[224:227], v[160:163], 0
    v_mfma_f32_16x16x32_bf16 v[176:179], v[228:231], v[164:167], v[176:179]
    v_mfma_f32_16x16x32_bf16 v[176:179], v[232:235], v[168:171], v[176:179]
    v_mfma_f32_16x16x32_bf16 v[176:179], v[236:239], v[172:175], v[176:179]
    v_mfma_f32_16x16x32_bf16 v[180:183], v[240:243], v[160:163], 0
    v_mfma_f32_16x16x32_bf16 v[180:183], v[244:247], v[164:167], v[180:183]
    v_mfma_f32_16x16x32_bf16 v[180:183], v[248:251], v[168:171], v[180:183]
    v_mfma_f32_16x16x32_bf16 v[180:183], v[252:255], v[172:175], v[180:183]
    s_nop 7
    s_nop 3
    v_cmp_gt_u32 vcc, 2, v2
    s_and_saveexec_b64 s[78:79], vcc
    v_cvt_pk_bf16_f32 v16, v176, v177
    v_cvt_pk_bf16_f32 v17, v178, v179
    buffer_store_dwordx2 v[16:17], v8, s[56:59], 0 offen offset:0 sc1
    v_cvt_pk_bf16_f32 v18, v180, v181
    v_cvt_pk_bf16_f32 v19, v182, v183
    buffer_store_dwordx2 v[18:19], v8, s[56:59], 0 offen offset:32 sc1
    s_mov_b64 exec, s[78:79]
    s_waitcnt vmcnt(0) lgkmcnt(0)
    s_barrier
    s_cmp_lg_u32 s64, 0
    s_cbranch_scc1 L_arr_skip_9
    v_mov_b32 v8, 1
    v_mov_b32 v9, 0
    s_mov_b64 exec, 1
    buffer_atomic_add v8, v9, s[84:87], 0 offen offset:0
    s_mov_b64 exec, -1
L_arr_skip_9:
    s_lshr_b32 s73, s2, 5
    s_and_b32 s74, s2, 31
    s_lshl_b32 s66, s73, 23
    s_lshl_b32 s67, s74, 18
    s_add_u32 s76, s66, s67
    s_add_u32 s60, s18, s76
    s_addc_u32 s61, s19, 0
    s_mov_b32 s62, 0x40000
    s_mov_b32 s63, 0x00020000
    v_and_b32 v8, 7, v1
    v_lshrrev_b32 v9, 3, v1
    v_lshlrev_b32 v10, 10, v9
    v_lshlrev_b32 v11, 4, v8
    v_add_u32 v10, v10, v11
    s_lshl_b32 s66, s64, 7
    v_add_u32 v31, s66, v10
    s_mov_b32 s66, 0
    buffer_load_dwordx4 v[32:35], v31, s[60:63], s66 offen nt
    s_add_u32 s66, s66, 8192
    buffer_load_dwordx4 v[36:39], v31, s[60:63], s66 offen nt
    s_add_u32 s66, s66, 8192
    buffer_load_dwordx4 v[40:43], v31, s[60:63], s66 offen nt
    s_add_u32 s66, s66, 8192
    buffer_load_dwordx4 v[44:47], v31, s[60:63], s66 offen nt
    s_add_u32 s66, s66, 8192
    buffer_load_dwordx4 v[48:51], v31, s[60:63], s66 offen nt
    s_add_u32 s66, s66, 8192
    buffer_load_dwordx4 v[52:55], v31, s[60:63], s66 offen nt
    s_add_u32 s66, s66, 8192
    buffer_load_dwordx4 v[56:59], v31, s[60:63], s66 offen nt
    s_add_u32 s66, s66, 8192
    buffer_load_dwordx4 v[60:63], v31, s[60:63], s66 offen nt
    s_add_u32 s66, s66, 8192
    buffer_load_dwordx4 v[64:67], v31, s[60:63], s66 offen nt
    s_add_u32 s66, s66, 8192
    buffer_load_dwordx4 v[68:71], v31, s[60:63], s66 offen nt
    s_add_u32 s66, s66, 8192
    buffer_load_dwordx4 v[72:75], v31, s[60:63], s66 offen nt
    s_add_u32 s66, s66, 8192
    buffer_load_dwordx4 v[76:79], v31, s[60:63], s66 offen nt
    s_add_u32 s66, s66, 8192
    buffer_load_dwordx4 v[80:83], v31, s[60:63], s66 offen nt
    s_add_u32 s66, s66, 8192
    buffer_load_dwordx4 v[84:87], v31, s[60:63], s66 offen nt
    s_add_u32 s66, s66, 8192
    buffer_load_dwordx4 v[88:91], v31, s[60:63], s66 offen nt
    s_add_u32 s66, s66, 8192
    buffer_load_dwordx4 v[92:95], v31, s[60:63], s66 offen nt
    s_add_u32 s66, s66, 8192
    buffer_load_dwordx4 v[96:99], v31, s[60:63], s66 offen nt
    s_add_u32 s66, s66, 8192
    buffer_load_dwordx4 v[100:103], v31, s[60:63], s66 offen nt
    s_add_u32 s66, s66, 8192
    buffer_load_dwordx4 v[104:107], v31, s[60:63], s66 offen nt
    s_add_u32 s66, s66, 8192
    buffer_load_dwordx4 v[108:111], v31, s[60:63], s66 offen nt
    s_add_u32 s66, s66, 8192
    buffer_load_dwordx4 v[112:115], v31, s[60:63], s66 offen nt
    s_add_u32 s66, s66, 8192
    buffer_load_dwordx4 v[116:119], v31, s[60:63], s66 offen nt
    s_add_u32 s66, s66, 8192
    buffer_load_dwordx4 v[120:123], v31, s[60:63], s66 offen nt
    s_add_u32 s66, s66, 8192
    buffer_load_dwordx4 v[124:127], v31, s[60:63], s66 offen nt
    s_add_u32 s66, s66, 8192
    buffer_load_dwordx4 v[128:131], v31, s[60:63], s66 offen nt
    s_add_u32 s66, s66, 8192
    buffer_load_dwordx4 v[132:135], v31, s[60:63], s66 offen nt
    s_add_u32 s66, s66, 8192
    buffer_load_dwordx4 v[136:139], v31, s[60:63], s66 offen nt
    s_add_u32 s66, s66, 8192
    buffer_load_dwordx4 v[140:143], v31, s[60:63], s66 offen nt
    s_add_u32 s66, s66, 8192
    buffer_load_dwordx4 v[144:147], v31, s[60:63], s66 offen nt
    s_add_u32 s66, s66, 8192
    buffer_load_dwordx4 v[148:151], v31, s[60:63], s66 offen nt
    s_add_u32 s66, s66, 8192
    buffer_load_dwordx4 v[152:155], v31, s[60:63], s66 offen nt
    s_add_u32 s66, s66, 8192
    buffer_load_dwordx4 v[156:159], v31, s[60:63], s66 offen nt
    s_cmp_lg_u32 s64, 0
    s_cbranch_scc1 L_sync_skip_10
    v_mov_b32 v9, 0
    s_mov_b32 s71, 0
L_sync_poll_11:
    buffer_load_dword v8, v9, s[84:87], 0 offen offset:0 sc1
    s_add_u32 s71, s71, 1
    s_waitcnt vmcnt(0)
    v_readfirstlane_b32 s70, v8
    s_cmp_ge_u32 s71, 0x40000
    s_cbranch_scc1 L_sync_done_12
    s_cmp_ge_u32 s70, 64
    s_cbranch_scc1 L_sync_done_12
    s_sleep 1
    s_branch L_sync_poll_11
L_sync_done_12:
L_sync_skip_10:
    s_barrier
    s_lshl_b32 s76, s73, 15
    s_add_u32 s48, s42, s76
    s_addc_u32 s49, s43, 0
    s_mov_b32 s50, 0x8000
    s_mov_b32 s51, 0x00020000
    v_and_b32 v8, 31, v1
    v_lshrrev_b32 v9, 5, v1
    v_lshlrev_b32 v11, 4, v9
    v_lshlrev_b32 v10, 10, v8
    v_add_u32 v10, v10, v11
    s_lshl_b32 s66, s64, 7
    v_add_u32 v10, s66, v10
    buffer_load_dwordx4 v[160:163], v10, s[48:51], 0 offen offset:0 sc1
    buffer_load_dwordx4 v[164:167], v10, s[48:51], 0 offen offset:32 sc1
    buffer_load_dwordx4 v[168:171], v10, s[48:51], 0 offen offset:64 sc1
    buffer_load_dwordx4 v[172:175], v10, s[48:51], 0 offen offset:96 sc1
    s_mul_i32 s66, s64, 9216
    s_add_u32 s66, s66, 73728
    v_mul_u32_u24 v24, 144, v8
    v_add_u32 v24, v24, v11
    v_add_u32 v24, s66, v24
    v_lshrrev_b32 v13, 3, v1
    v_mul_u32_u24 v13, 144, v13
    v_and_b32 v14, 7, v1
    v_lshlrev_b32 v14, 4, v14
    v_add_u32 v13, v13, v14
    v_add_u32 v13, s66, v13
    v_lshlrev_b32 v14, 4, v1
    s_lshl_b32 s67, s64, 13
    v_add_u32 v15, s67, v14
    s_lshr_b32 s67, s64, 1
    s_lshl_b32 s67, s67, 10
    s_and_b32 s68, s64, 1
    s_lshl_b32 s68, s68, 3
    s_add_u32 s67, s67, s68
    v_add_u32 v255, s67, v14
    v_lshrrev_b32 v8, 1, v3
    v_lshlrev_b32 v8, 2, v8
    v_lshrrev_b32 v9, 2, v2
    v_add_u32 v8, v8, v9
    v_mul_u32_u24 v8, 144, v8
    v_and_b32 v9, 1, v3
    v_lshlrev_b32 v9, 5, v9
    v_add_u32 v8, v8, v9
    v_and_b32 v9, 3, v2
    v_lshlrev_b32 v9, 3, v9
    v_add_u32 v8, v8, v9
    v_add_u32 v6, s66, v8
    v_mov_b32 v3, v13
    v_add_u32 v5, 65536, v14
    v_add_u32 v25, 65536, v255
    v_mov_b32 v4, v15
    v_mov_b32 v7, 0xff800000
    v_mov_b32 v252, 0
    v_mov_b32 v253, 0
    v_mov_b32 v176, 0
    v_mov_b32 v177, 0
    v_mov_b32 v178, 0
    v_mov_b32 v179, 0
    v_mov_b32 v180, 0
    v_mov_b32 v181, 0
    v_mov_b32 v182, 0
    v_mov_b32 v183, 0
    v_mov_b32 v184, 0
    v_mov_b32 v185, 0
    v_mov_b32 v186, 0
    v_mov_b32 v187, 0
    v_mov_b32 v188, 0
    v_mov_b32 v189, 0
    v_mov_b32 v190, 0
    v_mov_b32 v191, 0
    v_mov_b32 v192, 0
    v_mov_b32 v193, 0
    v_mov_b32 v194, 0
    v_mov_b32 v195, 0
    v_mov_b32 v196, 0
    v_mov_b32 v197, 0
    v_mov_b32 v198, 0
    v_mov_b32 v199, 0
    v_mov_b32 v200, 0
    v_mov_b32 v201, 0
    v_mov_b32 v202, 0
    v_mov_b32 v203, 0
    v_mov_b32 v204, 0
    v_mov_b32 v205, 0
    v_mov_b32 v206, 0
    v_mov_b32 v207, 0
    s_waitcnt vmcnt(0)
    ds_write_b128 v3, v[32:35] offset:0
    ds_write_b128 v3, v[36:39] offset:1152
    ds_write_b128 v3, v[40:43] offset:2304
    ds_write_b128 v3, v[44:47] offset:3456
    ds_write_b128 v3, v[48:51] offset:4608
    ds_write_b128 v3, v[52:55] offset:5760
    ds_write_b128 v3, v[56:59] offset:6912
    ds_write_b128 v3, v[60:63] offset:8064
    s_waitcnt lgkmcnt(0)
    ds_read_b128 v[8:11], v24 offset:0
    ds_read_b128 v[12:15], v24 offset:32
    ds_read_b128 v[16:19], v24 offset:64
    ds_read_b128 v[20:23], v24 offset:96
    s_waitcnt lgkmcnt(3)
    v_mfma_f32_32x32x16_bf16 v[208:223], v[8:11], v[160:163], 0
    s_waitcnt lgkmcnt(2)
    v_mfma_f32_32x32x16_bf16 v[208:223], v[12:15], v[164:167], v[208:223]
    s_waitcnt lgkmcnt(1)
    v_mfma_f32_32x32x16_bf16 v[208:223], v[16:19], v[168:171], v[208:223]
    s_waitcnt lgkmcnt(0)
    v_mfma_f32_32x32x16_bf16 v[208:223], v[20:23], v[172:175], v[208:223]
    ds_read_b128 v[8:11], v24 offset:4608
    ds_read_b128 v[12:15], v24 offset:4640
    ds_read_b128 v[16:19], v24 offset:4672
    ds_read_b128 v[20:23], v24 offset:4704
    s_waitcnt lgkmcnt(3)
    v_mfma_f32_32x32x16_bf16 v[224:239], v[8:11], v[160:163], 0
    s_waitcnt lgkmcnt(2)
    v_mfma_f32_32x32x16_bf16 v[224:239], v[12:15], v[164:167], v[224:239]
    s_waitcnt lgkmcnt(1)
    v_mfma_f32_32x32x16_bf16 v[224:239], v[16:19], v[168:171], v[224:239]
    s_waitcnt lgkmcnt(0)
    v_mfma_f32_32x32x16_bf16 v[224:239], v[20:23], v[172:175], v[224:239]
    s_nop 7
    ds_write_b128 v4, v[208:211] offset:0
    ds_write_b128 v4, v[212:215] offset:1024
    ds_write_b128 v4, v[216:219] offset:2048
    ds_write_b128 v4, v[220:223] offset:3072
    s_nop 3
    ds_write_b128 v4, v[224:227] offset:4096
    ds_write_b128 v4, v[228:231] offset:5120
    ds_write_b128 v4, v[232:235] offset:6144
    ds_write_b128 v4, v[236:239] offset:7168
    s_waitcnt lgkmcnt(0)
    s_barrier
    ds_read_b64 v[208:209], v255 offset:0
    ds_read_b64 v[210:211], v255 offset:8192
    ds_read_b64 v[212:213], v255 offset:16384
    ds_read_b64 v[214:215], v255 offset:24576
    ds_read_b64 v[216:217], v255 offset:32768
    ds_read_b64 v[218:219], v255 offset:40960
    ds_read_b64 v[220:221], v255 offset:49152
    ds_read_b64 v[222:223], v255 offset:57344
    ds_read_b64 v[224:225], v255 offset:4096
    ds_read_b64 v[226:227], v255 offset:12288
    ds_read_b64 v[228:229], v255 offset:20480
    ds_read_b64 v[230:231], v255 offset:28672
    ds_read_b64 v[232:233], v255 offset:36864
    ds_read_b64 v[234:235], v255 offset:45056
    ds_read_b64 v[236:237], v255 offset:53248
    ds_read_b64 v[238:239], v255 offset:61440
    s_waitcnt lgkmcnt(14)
    v_add_f32 v208, v208, v210
    v_add_f32 v209, v209, v211
    s_waitcnt lgkmcnt(13)
    v_add_f32 v208, v208, v212
    v_add_f32 v209, v209, v213
    s_waitcnt lgkmcnt(12)
    v_add_f32 v208, v208, v214
    v_add_f32 v209, v209, v215
    s_waitcnt lgkmcnt(11)
    v_add_f32 v208, v208, v216
    v_add_f32 v209, v209, v217
    s_waitcnt lgkmcnt(10)
    v_add_f32 v208, v208, v218
    v_add_f32 v209, v209, v219
    s_waitcnt lgkmcnt(9)
    v_add_f32 v208, v208, v220
    v_add_f32 v209, v209, v221
    s_waitcnt lgkmcnt(8)
    v_add_f32 v208, v208, v222
    v_add_f32 v209, v209, v223
    s_waitcnt lgkmcnt(6)
    v_add_f32 v224, v224, v226
    v_add_f32 v225, v225, v227
    s_waitcnt lgkmcnt(5)
    v_add_f32 v224, v224, v228
    v_add_f32 v225, v225, v229
    s_waitcnt lgkmcnt(4)
    v_add_f32 v224, v224, v230
    v_add_f32 v225, v225, v231
    s_waitcnt lgkmcnt(3)
    v_add_f32 v224, v224, v232
    v_add_f32 v225, v225, v233
    s_waitcnt lgkmcnt(2)
    v_add_f32 v224, v224, v234
    v_add_f32 v225, v225, v235
    s_waitcnt lgkmcnt(1)
    v_add_f32 v224, v224, v236
    v_add_f32 v225, v225, v237
    s_waitcnt lgkmcnt(0)
    v_add_f32 v224, v224, v238
    v_add_f32 v225, v225, v239
    ds_write_b64 v25, v[208:209]
    ds_write_b64 v25, v[224:225] offset:4096
    s_waitcnt lgkmcnt(0)
    s_barrier
    ds_read_b128 v[208:211], v5 offset:0
    ds_read_b128 v[212:215], v5 offset:1024
    ds_read_b128 v[216:219], v5 offset:2048
    ds_read_b128 v[220:223], v5 offset:3072
    ds_read_b128 v[224:227], v5 offset:4096
    ds_read_b128 v[228:231], v5 offset:5120
    ds_read_b128 v[232:235], v5 offset:6144
    ds_read_b128 v[236:239], v5 offset:7168
    ds_read_b64_tr_b16 v[240:241], v6 offset:0
    ds_read_b64_tr_b16 v[242:243], v6 offset:1152
    ds_read_b64_tr_b16 v[244:245], v6 offset:64
    ds_read_b64_tr_b16 v[246:247], v6 offset:1216
    ds_read_b64_tr_b16 v[248:249], v6 offset:2304
    ds_read_b64_tr_b16 v[250:251], v6 offset:3456
    s_waitcnt lgkmcnt(6)
    v_max3_f32 v254, v208, v209, v210
    v_max3_f32 v254, v254, v211, v212
    v_max3_f32 v254, v254, v213, v214
    v_max3_f32 v254, v254, v215, v216
    v_max3_f32 v254, v254, v217, v218
    v_max3_f32 v254, v254, v219, v220
    v_max3_f32 v254, v254, v221, v222
    v_max3_f32 v254, v254, v223, v224
    v_max3_f32 v254, v254, v225, v226
    v_max3_f32 v254, v254, v227, v228
    v_max3_f32 v254, v254, v229, v230
    v_max3_f32 v254, v254, v231, v232
    v_max3_f32 v254, v254, v233, v234
    v_max3_f32 v254, v254, v235, v236
    v_max3_f32 v254, v254, v237, v238
    v_max_f32 v254, v254, v239
    v_cmp_gt_f32 vcc, v254, v7
    s_cbranch_vccnz L_arare_13
L_aback_14:
    v_fma_f32 v208, v208, s65, v253
    v_fma_f32 v209, v209, s65, v253
    v_fma_f32 v210, v210, s65, v253
    v_fma_f32 v211, v211, s65, v253
    v_fma_f32 v212, v212, s65, v253
    v_fma_f32 v213, v213, s65, v253
    v_fma_f32 v214, v214, s65, v253
    v_fma_f32 v215, v215, s65, v253
    v_fma_f32 v216, v216, s65, v253
    v_fma_f32 v217, v217, s65, v253
    v_fma_f32 v218, v218, s65, v253
    v_fma_f32 v219, v219, s65, v253
    v_fma_f32 v220, v220, s65, v253
    v_fma_f32 v221, v221, s65, v253
    v_fma_f32 v222, v222, s65, v253
    v_fma_f32 v223, v223, s65, v253
    v_fma_f32 v224, v224, s65, v253
    v_fma_f32 v225, v225, s65, v253
    v_fma_f32 v226, v226, s65, v253
    v_fma_f32 v227, v227, s65, v253
    v_fma_f32 v228, v228, s65, v253
    v_fma_f32 v229, v229, s65, v253
    v_fma_f32 v230, v230, s65, v253
    v_fma_f32 v231, v231, s65, v253
    v_fma_f32 v232, v232, s65, v253
    v_fma_f32 v233, v233, s65, v253
    v_fma_f32 v234, v234, s65, v253
    v_fma_f32 v235, v235, s65, v253
    v_fma_f32 v236, v236, s65, v253
    v_fma_f32 v237, v237, s65, v253
    v_fma_f32 v238, v238, s65, v253
    v_fma_f32 v239, v239, s65, v253
    v_exp_f32 v208, v208
    v_exp_f32 v209, v209
    v_exp_f32 v210, v210
    v_exp_f32 v211, v211
    v_exp_f32 v212, v212
    v_exp_f32 v213, v213
    v_exp_f32 v214, v214
    v_exp_f32 v215, v215
    v_exp_f32 v216, v216
    v_exp_f32 v217, v217
    v_exp_f32 v218, v218
    v_exp_f32 v219, v219
    v_exp_f32 v220, v220
    v_exp_f32 v221, v221
    v_exp_f32 v222, v222
    v_exp_f32 v223, v223
    v_exp_f32 v224, v224
    v_exp_f32 v225, v225
    v_exp_f32 v226, v226
    v_exp_f32 v227, v227
    v_exp_f32 v228, v228
    v_exp_f32 v229, v229
    v_exp_f32 v230, v230
    v_exp_f32 v231, v231
    v_exp_f32 v232, v232
    v_exp_f32 v233, v233
    v_exp_f32 v234, v234
    v_exp_f32 v235, v235
    v_exp_f32 v236, v236
    v_exp_f32 v237, v237
    v_exp_f32 v238, v238
    v_exp_f32 v239, v239
    s_nop 0
    v_cvt_pk_bf16_f32 v8, v208, v209
    v_cvt_pk_bf16_f32 v9, v210, v211
    v_cvt_pk_bf16_f32 v10, v212, v213
    v_cvt_pk_bf16_f32 v11, v214, v215
    v_cvt_pk_bf16_f32 v12, v216, v217
    v_cvt_pk_bf16_f32 v13, v218, v219
    v_cvt_pk_bf16_f32 v14, v220, v221
    v_cvt_pk_bf16_f32 v15, v222, v223
    v_cvt_pk_bf16_f32 v16, v224, v225
    v_cvt_pk_bf16_f32 v17, v226, v227
    v_cvt_pk_bf16_f32 v18, v228, v229
    v_cvt_pk_bf16_f32 v19, v230, v231
    v_cvt_pk_bf16_f32 v20, v232, v233
    v_cvt_pk_bf16_f32 v21, v234, v235
    v_cvt_pk_bf16_f32 v22, v236, v237
    v_cvt_pk_bf16_f32 v23, v238, v239
    s_nop 1
    s_waitcnt lgkmcnt(4)
    v_mfma_f32_32x32x16_bf16 v[176:191], v[240:243], v[8:11], v[176:191]
    ds_read_b64_tr_b16 v[240:241], v6 offset:2368
    ds_read_b64_tr_b16 v[242:243], v6 offset:3520
    v_add_f32 v208, v208, v209
    v_add_f32 v210, v210, v211
    v_add_f32 v212, v212, v213
    v_add_f32 v214, v214, v215
    s_waitcnt lgkmcnt(4)
    v_mfma_f32_32x32x16_bf16 v[192:207], v[244:247], v[8:11], v[192:207]
    ds_read_b64_tr_b16 v[244:245], v6 offset:4608
    ds_read_b64_tr_b16 v[246:247], v6 offset:5760
    v_add_f32 v216, v216, v217
    v_add_f32 v218, v218, v219
    v_add_f32 v220, v220, v221
    v_add_f32 v222, v222, v223
    s_waitcnt lgkmcnt(4)
    v_mfma_f32_32x32x16_bf16 v[176:191], v[248:251], v[12:15], v[176:191]
    ds_read_b64_tr_b16 v[248:249], v6 offset:4672
    ds_read_b64_tr_b16 v[250:251], v6 offset:5824
    v_add_f32 v224, v224, v225
    v_add_f32 v226, v226, v227
    v_add_f32 v228, v228, v229
    v_add_f32 v230, v230, v231
    s_waitcnt lgkmcnt(4)
    v_mfma_f32_32x32x16_bf16 v[192:207], v[240:243], v[12:15], v[192:207]
    ds_read_b64_tr_b16 v[240:241], v6 offset:6912
    ds_read_b64_tr_b16 v[242:243], v6 offset:8064
    v_add_f32 v232, v232, v233
    v_add_f32 v234, v234, v235
    v_add_f32 v236, v236, v237
    v_add_f32 v238, v238, v239
    s_waitcnt lgkmcnt(4)
    v_mfma_f32_32x32x16_bf16 v[176:191], v[244:247], v[16:19], v[176:191]
    ds_read_b64_tr_b16 v[244:245], v6 offset:6976
    ds_read_b64_tr_b16 v[246:247], v6 offset:8128
    v_add_f32 v208, v208, v210
    v_add_f32 v212, v212, v214
    v_add_f32 v216, v216, v218
    v_add_f32 v220, v220, v222
    s_waitcnt lgkmcnt(4)
    v_mfma_f32_32x32x16_bf16 v[192:207], v[248:251], v[16:19], v[192:207]
    v_add_f32 v224, v224, v226
    v_add_f32 v228, v228, v230
    v_add_f32 v232, v232, v234
    v_add_f32 v236, v236, v238
    s_waitcnt lgkmcnt(2)
    v_mfma_f32_32x32x16_bf16 v[176:191], v[240:243], v[20:23], v[176:191]
    v_add_f32 v208, v208, v212
    v_add_f32 v216, v216, v220
    v_add_f32 v224, v224, v228
    v_add_f32 v232, v232, v236
    s_waitcnt lgkmcnt(0)
    v_mfma_f32_32x32x16_bf16 v[192:207], v[244:247], v[20:23], v[192:207]
    v_add_f32 v208, v208, v216
    v_add_f32 v224, v224, v232
    v_add_f32 v208, v208, v224
    v_add_f32 v252, v252, v208
    ds_write_b128 v3, v[64:67] offset:0
    ds_write_b128 v3, v[68:71] offset:1152
    ds_write_b128 v3, v[72:75] offset:2304
    ds_write_b128 v3, v[76:79] offset:3456
    ds_write_b128 v3, v[80:83] offset:4608
    ds_write_b128 v3, v[84:87] offset:5760
    ds_write_b128 v3, v[88:91] offset:6912
    ds_write_b128 v3, v[92:95] offset:8064
    s_waitcnt lgkmcnt(0)
    ds_read_b128 v[8:11], v24 offset:0
    ds_read_b128 v[12:15], v24 offset:32
    ds_read_b128 v[16:19], v24 offset:64
    ds_read_b128 v[20:23], v24 offset:96
    s_waitcnt lgkmcnt(3)
    v_mfma_f32_32x32x16_bf16 v[208:223], v[8:11], v[160:163], 0
    s_waitcnt lgkmcnt(2)
    v_mfma_f32_32x32x16_bf16 v[208:223], v[12:15], v[164:167], v[208:223]
    s_waitcnt lgkmcnt(1)
    v_mfma_f32_32x32x16_bf16 v[208:223], v[16:19], v[168:171], v[208:223]
    s_waitcnt lgkmcnt(0)
    v_mfma_f32_32x32x16_bf16 v[208:223], v[20:23], v[172:175], v[208:223]
    ds_read_b128 v[8:11], v24 offset:4608
    ds_read_b128 v[12:15], v24 offset:4640
    ds_read_b128 v[16:19], v24 offset:4672
    ds_read_b128 v[20:23], v24 offset:4704
    s_waitcnt lgkmcnt(3)
    v_mfma_f32_32x32x16_bf16 v[224:239], v[8:11], v[160:163], 0
    s_waitcnt lgkmcnt(2)
    v_mfma_f32_32x32x16_bf16 v[224:239], v[12:15], v[164:167], v[224:239]
    s_waitcnt lgkmcnt(1)
    v_mfma_f32_32x32x16_bf16 v[224:239], v[16:19], v[168:171], v[224:239]
    s_waitcnt lgkmcnt(0)
    v_mfma_f32_32x32x16_bf16 v[224:239], v[20:23], v[172:175], v[224:239]
    s_nop 7
    ds_write_b128 v4, v[208:211] offset:0
    ds_write_b128 v4, v[212:215] offset:1024
    ds_write_b128 v4, v[216:219] offset:2048
    ds_write_b128 v4, v[220:223] offset:3072
    s_nop 3
    ds_write_b128 v4, v[224:227] offset:4096
    ds_write_b128 v4, v[228:231] offset:5120
    ds_write_b128 v4, v[232:235] offset:6144
    ds_write_b128 v4, v[236:239] offset:7168
    s_waitcnt lgkmcnt(0)
    s_barrier
    ds_read_b64 v[208:209], v255 offset:0
    ds_read_b64 v[210:211], v255 offset:8192
    ds_read_b64 v[212:213], v255 offset:16384
    ds_read_b64 v[214:215], v255 offset:24576
    ds_read_b64 v[216:217], v255 offset:32768
    ds_read_b64 v[218:219], v255 offset:40960
    ds_read_b64 v[220:221], v255 offset:49152
    ds_read_b64 v[222:223], v255 offset:57344
    ds_read_b64 v[224:225], v255 offset:4096
    ds_read_b64 v[226:227], v255 offset:12288
    ds_read_b64 v[228:229], v255 offset:20480
    ds_read_b64 v[230:231], v255 offset:28672
    ds_read_b64 v[232:233], v255 offset:36864
    ds_read_b64 v[234:235], v255 offset:45056
    ds_read_b64 v[236:237], v255 offset:53248
    ds_read_b64 v[238:239], v255 offset:61440
    s_waitcnt lgkmcnt(14)
    v_add_f32 v208, v208, v210
    v_add_f32 v209, v209, v211
    s_waitcnt lgkmcnt(13)
    v_add_f32 v208, v208, v212
    v_add_f32 v209, v209, v213
    s_waitcnt lgkmcnt(12)
    v_add_f32 v208, v208, v214
    v_add_f32 v209, v209, v215
    s_waitcnt lgkmcnt(11)
    v_add_f32 v208, v208, v216
    v_add_f32 v209, v209, v217
    s_waitcnt lgkmcnt(10)
    v_add_f32 v208, v208, v218
    v_add_f32 v209, v209, v219
    s_waitcnt lgkmcnt(9)
    v_add_f32 v208, v208, v220
    v_add_f32 v209, v209, v221
    s_waitcnt lgkmcnt(8)
    v_add_f32 v208, v208, v222
    v_add_f32 v209, v209, v223
    s_waitcnt lgkmcnt(6)
    v_add_f32 v224, v224, v226
    v_add_f32 v225, v225, v227
    s_waitcnt lgkmcnt(5)
    v_add_f32 v224, v224, v228
    v_add_f32 v225, v225, v229
    s_waitcnt lgkmcnt(4)
    v_add_f32 v224, v224, v230
    v_add_f32 v225, v225, v231
    s_waitcnt lgkmcnt(3)
    v_add_f32 v224, v224, v232
    v_add_f32 v225, v225, v233
    s_waitcnt lgkmcnt(2)
    v_add_f32 v224, v224, v234
    v_add_f32 v225, v225, v235
    s_waitcnt lgkmcnt(1)
    v_add_f32 v224, v224, v236
    v_add_f32 v225, v225, v237
    s_waitcnt lgkmcnt(0)
    v_add_f32 v224, v224, v238
    v_add_f32 v225, v225, v239
    ds_write_b64 v25, v[208:209]
    ds_write_b64 v25, v[224:225] offset:4096
    s_waitcnt lgkmcnt(0)
    s_barrier
    ds_read_b128 v[208:211], v5 offset:0
    ds_read_b128 v[212:215], v5 offset:1024
    ds_read_b128 v[216:219], v5 offset:2048
    ds_read_b128 v[220:223], v5 offset:3072
    ds_read_b128 v[224:227], v5 offset:4096
    ds_read_b128 v[228:231], v5 offset:5120
    ds_read_b128 v[232:235], v5 offset:6144
    ds_read_b128 v[236:239], v5 offset:7168
    ds_read_b64_tr_b16 v[240:241], v6 offset:0
    ds_read_b64_tr_b16 v[242:243], v6 offset:1152
    ds_read_b64_tr_b16 v[244:245], v6 offset:64
    ds_read_b64_tr_b16 v[246:247], v6 offset:1216
    ds_read_b64_tr_b16 v[248:249], v6 offset:2304
    ds_read_b64_tr_b16 v[250:251], v6 offset:3456
    s_waitcnt lgkmcnt(6)
    v_max3_f32 v254, v208, v209, v210
    v_max3_f32 v254, v254, v211, v212
    v_max3_f32 v254, v254, v213, v214
    v_max3_f32 v254, v254, v215, v216
    v_max3_f32 v254, v254, v217, v218
    v_max3_f32 v254, v254, v219, v220
    v_max3_f32 v254, v254, v221, v222
    v_max3_f32 v254, v254, v223, v224
    v_max3_f32 v254, v254, v225, v226
    v_max3_f32 v254, v254, v227, v228
    v_max3_f32 v254, v254, v229, v230
    v_max3_f32 v254, v254, v231, v232
    v_max3_f32 v254, v254, v233, v234
    v_max3_f32 v254, v254, v235, v236
    v_max3_f32 v254, v254, v237, v238
    v_max_f32 v254, v254, v239
    v_cmp_gt_f32 vcc, v254, v7
    s_cbranch_vccnz L_arare_15
L_aback_16:
    v_fma_f32 v208, v208, s65, v253
    v_fma_f32 v209, v209, s65, v253
    v_fma_f32 v210, v210, s65, v253
    v_fma_f32 v211, v211, s65, v253
    v_fma_f32 v212, v212, s65, v253
    v_fma_f32 v213, v213, s65, v253
    v_fma_f32 v214, v214, s65, v253
    v_fma_f32 v215, v215, s65, v253
    v_fma_f32 v216, v216, s65, v253
    v_fma_f32 v217, v217, s65, v253
    v_fma_f32 v218, v218, s65, v253
    v_fma_f32 v219, v219, s65, v253
    v_fma_f32 v220, v220, s65, v253
    v_fma_f32 v221, v221, s65, v253
    v_fma_f32 v222, v222, s65, v253
    v_fma_f32 v223, v223, s65, v253
    v_fma_f32 v224, v224, s65, v253
    v_fma_f32 v225, v225, s65, v253
    v_fma_f32 v226, v226, s65, v253
    v_fma_f32 v227, v227, s65, v253
    v_fma_f32 v228, v228, s65, v253
    v_fma_f32 v229, v229, s65, v253
    v_fma_f32 v230, v230, s65, v253
    v_fma_f32 v231, v231, s65, v253
    v_fma_f32 v232, v232, s65, v253
    v_fma_f32 v233, v233, s65, v253
    v_fma_f32 v234, v234, s65, v253
    v_fma_f32 v235, v235, s65, v253
    v_fma_f32 v236, v236, s65, v253
    v_fma_f32 v237, v237, s65, v253
    v_fma_f32 v238, v238, s65, v253
    v_fma_f32 v239, v239, s65, v253
    v_exp_f32 v208, v208
    v_exp_f32 v209, v209
    v_exp_f32 v210, v210
    v_exp_f32 v211, v211
    v_exp_f32 v212, v212
    v_exp_f32 v213, v213
    v_exp_f32 v214, v214
    v_exp_f32 v215, v215
    v_exp_f32 v216, v216
    v_exp_f32 v217, v217
    v_exp_f32 v218, v218
    v_exp_f32 v219, v219
    v_exp_f32 v220, v220
    v_exp_f32 v221, v221
    v_exp_f32 v222, v222
    v_exp_f32 v223, v223
    v_exp_f32 v224, v224
    v_exp_f32 v225, v225
    v_exp_f32 v226, v226
    v_exp_f32 v227, v227
    v_exp_f32 v228, v228
    v_exp_f32 v229, v229
    v_exp_f32 v230, v230
    v_exp_f32 v231, v231
    v_exp_f32 v232, v232
    v_exp_f32 v233, v233
    v_exp_f32 v234, v234
    v_exp_f32 v235, v235
    v_exp_f32 v236, v236
    v_exp_f32 v237, v237
    v_exp_f32 v238, v238
    v_exp_f32 v239, v239
    s_nop 0
    v_cvt_pk_bf16_f32 v8, v208, v209
    v_cvt_pk_bf16_f32 v9, v210, v211
    v_cvt_pk_bf16_f32 v10, v212, v213
    v_cvt_pk_bf16_f32 v11, v214, v215
    v_cvt_pk_bf16_f32 v12, v216, v217
    v_cvt_pk_bf16_f32 v13, v218, v219
    v_cvt_pk_bf16_f32 v14, v220, v221
    v_cvt_pk_bf16_f32 v15, v222, v223
    v_cvt_pk_bf16_f32 v16, v224, v225
    v_cvt_pk_bf16_f32 v17, v226, v227
    v_cvt_pk_bf16_f32 v18, v228, v229
    v_cvt_pk_bf16_f32 v19, v230, v231
    v_cvt_pk_bf16_f32 v20, v232, v233
    v_cvt_pk_bf16_f32 v21, v234, v235
    v_cvt_pk_bf16_f32 v22, v236, v237
    v_cvt_pk_bf16_f32 v23, v238, v239
    s_nop 1
    s_waitcnt lgkmcnt(4)
    v_mfma_f32_32x32x16_bf16 v[176:191], v[240:243], v[8:11], v[176:191]
    ds_read_b64_tr_b16 v[240:241], v6 offset:2368
    ds_read_b64_tr_b16 v[242:243], v6 offset:3520
    v_add_f32 v208, v208, v209
    v_add_f32 v210, v210, v211
    v_add_f32 v212, v212, v213
    v_add_f32 v214, v214, v215
    s_waitcnt lgkmcnt(4)
    v_mfma_f32_32x32x16_bf16 v[192:207], v[244:247], v[8:11], v[192:207]
    ds_read_b64_tr_b16 v[244:245], v6 offset:4608
    ds_read_b64_tr_b16 v[246:247], v6 offset:5760
    v_add_f32 v216, v216, v217
    v_add_f32 v218, v218, v219
    v_add_f32 v220, v220, v221
    v_add_f32 v222, v222, v223
    s_waitcnt lgkmcnt(4)
    v_mfma_f32_32x32x16_bf16 v[176:191], v[248:251], v[12:15], v[176:191]
    ds_read_b64_tr_b16 v[248:249], v6 offset:4672
    ds_read_b64_tr_b16 v[250:251], v6 offset:5824
    v_add_f32 v224, v224, v225
    v_add_f32 v226, v226, v227
    v_add_f32 v228, v228, v229
    v_add_f32 v230, v230, v231
    s_waitcnt lgkmcnt(4)
    v_mfma_f32_32x32x16_bf16 v[192:207], v[240:243], v[12:15], v[192:207]
    ds_read_b64_tr_b16 v[240:241], v6 offset:6912
    ds_read_b64_tr_b16 v[242:243], v6 offset:8064
    v_add_f32 v232, v232, v233
    v_add_f32 v234, v234, v235
    v_add_f32 v236, v236, v237
    v_add_f32 v238, v238, v239
    s_waitcnt lgkmcnt(4)
    v_mfma_f32_32x32x16_bf16 v[176:191], v[244:247], v[16:19], v[176:191]
    ds_read_b64_tr_b16 v[244:245], v6 offset:6976
    ds_read_b64_tr_b16 v[246:247], v6 offset:8128
    v_add_f32 v208, v208, v210
    v_add_f32 v212, v212, v214
    v_add_f32 v216, v216, v218
    v_add_f32 v220, v220, v222
    s_waitcnt lgkmcnt(4)
    v_mfma_f32_32x32x16_bf16 v[192:207], v[248:251], v[16:19], v[192:207]
    v_add_f32 v224, v224, v226
    v_add_f32 v228, v228, v230
    v_add_f32 v232, v232, v234
    v_add_f32 v236, v236, v238
    s_waitcnt lgkmcnt(2)
    v_mfma_f32_32x32x16_bf16 v[176:191], v[240:243], v[20:23], v[176:191]
    v_add_f32 v208, v208, v212
    v_add_f32 v216, v216, v220
    v_add_f32 v224, v224, v228
    v_add_f32 v232, v232, v236
    s_waitcnt lgkmcnt(0)
    v_mfma_f32_32x32x16_bf16 v[192:207], v[244:247], v[20:23], v[192:207]
    v_add_f32 v208, v208, v216
    v_add_f32 v224, v224, v232
    v_add_f32 v208, v208, v224
    v_add_f32 v252, v252, v208
    ds_write_b128 v3, v[96:99] offset:0
    ds_write_b128 v3, v[100:103] offset:1152
    ds_write_b128 v3, v[104:107] offset:2304
    ds_write_b128 v3, v[108:111] offset:3456
    ds_write_b128 v3, v[112:115] offset:4608
    ds_write_b128 v3, v[116:119] offset:5760
    ds_write_b128 v3, v[120:123] offset:6912
    ds_write_b128 v3, v[124:127] offset:8064
    s_waitcnt lgkmcnt(0)
    ds_read_b128 v[8:11], v24 offset:0
    ds_read_b128 v[12:15], v24 offset:32
    ds_read_b128 v[16:19], v24 offset:64
    ds_read_b128 v[20:23], v24 offset:96
    s_waitcnt lgkmcnt(3)
    v_mfma_f32_32x32x16_bf16 v[208:223], v[8:11], v[160:163], 0
    s_waitcnt lgkmcnt(2)
    v_mfma_f32_32x32x16_bf16 v[208:223], v[12:15], v[164:167], v[208:223]
    s_waitcnt lgkmcnt(1)
    v_mfma_f32_32x32x16_bf16 v[208:223], v[16:19], v[168:171], v[208:223]
    s_waitcnt lgkmcnt(0)
    v_mfma_f32_32x32x16_bf16 v[208:223], v[20:23], v[172:175], v[208:223]
    ds_read_b128 v[8:11], v24 offset:4608
    ds_read_b128 v[12:15], v24 offset:4640
    ds_read_b128 v[16:19], v24 offset:4672
    ds_read_b128 v[20:23], v24 offset:4704
    s_waitcnt lgkmcnt(3)
    v_mfma_f32_32x32x16_bf16 v[224:239], v[8:11], v[160:163], 0
    s_waitcnt lgkmcnt(2)
    v_mfma_f32_32x32x16_bf16 v[224:239], v[12:15], v[164:167], v[224:239]
    s_waitcnt lgkmcnt(1)
    v_mfma_f32_32x32x16_bf16 v[224:239], v[16:19], v[168:171], v[224:239]
    s_waitcnt lgkmcnt(0)
    v_mfma_f32_32x32x16_bf16 v[224:239], v[20:23], v[172:175], v[224:239]
    s_nop 7
    ds_write_b128 v4, v[208:211] offset:0
    ds_write_b128 v4, v[212:215] offset:1024
    ds_write_b128 v4, v[216:219] offset:2048
    ds_write_b128 v4, v[220:223] offset:3072
    s_nop 3
    ds_write_b128 v4, v[224:227] offset:4096
    ds_write_b128 v4, v[228:231] offset:5120
    ds_write_b128 v4, v[232:235] offset:6144
    ds_write_b128 v4, v[236:239] offset:7168
    s_waitcnt lgkmcnt(0)
    s_barrier
    ds_read_b64 v[208:209], v255 offset:0
    ds_read_b64 v[210:211], v255 offset:8192
    ds_read_b64 v[212:213], v255 offset:16384
    ds_read_b64 v[214:215], v255 offset:24576
    ds_read_b64 v[216:217], v255 offset:32768
    ds_read_b64 v[218:219], v255 offset:40960
    ds_read_b64 v[220:221], v255 offset:49152
    ds_read_b64 v[222:223], v255 offset:57344
    ds_read_b64 v[224:225], v255 offset:4096
    ds_read_b64 v[226:227], v255 offset:12288
    ds_read_b64 v[228:229], v255 offset:20480
    ds_read_b64 v[230:231], v255 offset:28672
    ds_read_b64 v[232:233], v255 offset:36864
    ds_read_b64 v[234:235], v255 offset:45056
    ds_read_b64 v[236:237], v255 offset:53248
    ds_read_b64 v[238:239], v255 offset:61440
    s_waitcnt lgkmcnt(14)
    v_add_f32 v208, v208, v210
    v_add_f32 v209, v209, v211
    s_waitcnt lgkmcnt(13)
    v_add_f32 v208, v208, v212
    v_add_f32 v209, v209, v213
    s_waitcnt lgkmcnt(12)
    v_add_f32 v208, v208, v214
    v_add_f32 v209, v209, v215
    s_waitcnt lgkmcnt(11)
    v_add_f32 v208, v208, v216
    v_add_f32 v209, v209, v217
    s_waitcnt lgkmcnt(10)
    v_add_f32 v208, v208, v218
    v_add_f32 v209, v209, v219
    s_waitcnt lgkmcnt(9)
    v_add_f32 v208, v208, v220
    v_add_f32 v209, v209, v221
    s_waitcnt lgkmcnt(8)
    v_add_f32 v208, v208, v222
    v_add_f32 v209, v209, v223
    s_waitcnt lgkmcnt(6)
    v_add_f32 v224, v224, v226
    v_add_f32 v225, v225, v227
    s_waitcnt lgkmcnt(5)
    v_add_f32 v224, v224, v228
    v_add_f32 v225, v225, v229
    s_waitcnt lgkmcnt(4)
    v_add_f32 v224, v224, v230
    v_add_f32 v225, v225, v231
    s_waitcnt lgkmcnt(3)
    v_add_f32 v224, v224, v232
    v_add_f32 v225, v225, v233
    s_waitcnt lgkmcnt(2)
    v_add_f32 v224, v224, v234
    v_add_f32 v225, v225, v235
    s_waitcnt lgkmcnt(1)
    v_add_f32 v224, v224, v236
    v_add_f32 v225, v225, v237
    s_waitcnt lgkmcnt(0)
    v_add_f32 v224, v224, v238
    v_add_f32 v225, v225, v239
    ds_write_b64 v25, v[208:209]
    ds_write_b64 v25, v[224:225] offset:4096
    s_waitcnt lgkmcnt(0)
    s_barrier
    ds_read_b128 v[208:211], v5 offset:0
    ds_read_b128 v[212:215], v5 offset:1024
    ds_read_b128 v[216:219], v5 offset:2048
    ds_read_b128 v[220:223], v5 offset:3072
    ds_read_b128 v[224:227], v5 offset:4096
    ds_read_b128 v[228:231], v5 offset:5120
    ds_read_b128 v[232:235], v5 offset:6144
    ds_read_b128 v[236:239], v5 offset:7168
    ds_read_b64_tr_b16 v[240:241], v6 offset:0
    ds_read_b64_tr_b16 v[242:243], v6 offset:1152
    ds_read_b64_tr_b16 v[244:245], v6 offset:64
    ds_read_b64_tr_b16 v[246:247], v6 offset:1216
    ds_read_b64_tr_b16 v[248:249], v6 offset:2304
    ds_read_b64_tr_b16 v[250:251], v6 offset:3456
    s_waitcnt lgkmcnt(6)
    v_max3_f32 v254, v208, v209, v210
    v_max3_f32 v254, v254, v211, v212
    v_max3_f32 v254, v254, v213, v214
    v_max3_f32 v254, v254, v215, v216
    v_max3_f32 v254, v254, v217, v218
    v_max3_f32 v254, v254, v219, v220
    v_max3_f32 v254, v254, v221, v222
    v_max3_f32 v254, v254, v223, v224
    v_max3_f32 v254, v254, v225, v226
    v_max3_f32 v254, v254, v227, v228
    v_max3_f32 v254, v254, v229, v230
    v_max3_f32 v254, v254, v231, v232
    v_max3_f32 v254, v254, v233, v234
    v_max3_f32 v254, v254, v235, v236
    v_max3_f32 v254, v254, v237, v238
    v_max_f32 v254, v254, v239
    v_cmp_gt_f32 vcc, v254, v7
    s_cbranch_vccnz L_arare_17
L_aback_18:
    v_fma_f32 v208, v208, s65, v253
    v_fma_f32 v209, v209, s65, v253
    v_fma_f32 v210, v210, s65, v253
    v_fma_f32 v211, v211, s65, v253
    v_fma_f32 v212, v212, s65, v253
    v_fma_f32 v213, v213, s65, v253
    v_fma_f32 v214, v214, s65, v253
    v_fma_f32 v215, v215, s65, v253
    v_fma_f32 v216, v216, s65, v253
    v_fma_f32 v217, v217, s65, v253
    v_fma_f32 v218, v218, s65, v253
    v_fma_f32 v219, v219, s65, v253
    v_fma_f32 v220, v220, s65, v253
    v_fma_f32 v221, v221, s65, v253
    v_fma_f32 v222, v222, s65, v253
    v_fma_f32 v223, v223, s65, v253
    v_fma_f32 v224, v224, s65, v253
    v_fma_f32 v225, v225, s65, v253
    v_fma_f32 v226, v226, s65, v253
    v_fma_f32 v227, v227, s65, v253
    v_fma_f32 v228, v228, s65, v253
    v_fma_f32 v229, v229, s65, v253
    v_fma_f32 v230, v230, s65, v253
    v_fma_f32 v231, v231, s65, v253
    v_fma_f32 v232, v232, s65, v253
    v_fma_f32 v233, v233, s65, v253
    v_fma_f32 v234, v234, s65, v253
    v_fma_f32 v235, v235, s65, v253
    v_fma_f32 v236, v236, s65, v253
    v_fma_f32 v237, v237, s65, v253
    v_fma_f32 v238, v238, s65, v253
    v_fma_f32 v239, v239, s65, v253
    v_exp_f32 v208, v208
    v_exp_f32 v209, v209
    v_exp_f32 v210, v210
    v_exp_f32 v211, v211
    v_exp_f32 v212, v212
    v_exp_f32 v213, v213
    v_exp_f32 v214, v214
    v_exp_f32 v215, v215
    v_exp_f32 v216, v216
    v_exp_f32 v217, v217
    v_exp_f32 v218, v218
    v_exp_f32 v219, v219
    v_exp_f32 v220, v220
    v_exp_f32 v221, v221
    v_exp_f32 v222, v222
    v_exp_f32 v223, v223
    v_exp_f32 v224, v224
    v_exp_f32 v225, v225
    v_exp_f32 v226, v226
    v_exp_f32 v227, v227
    v_exp_f32 v228, v228
    v_exp_f32 v229, v229
    v_exp_f32 v230, v230
    v_exp_f32 v231, v231
    v_exp_f32 v232, v232
    v_exp_f32 v233, v233
    v_exp_f32 v234, v234
    v_exp_f32 v235, v235
    v_exp_f32 v236, v236
    v_exp_f32 v237, v237
    v_exp_f32 v238, v238
    v_exp_f32 v239, v239
    s_nop 0
    v_cvt_pk_bf16_f32 v8, v208, v209
    v_cvt_pk_bf16_f32 v9, v210, v211
    v_cvt_pk_bf16_f32 v10, v212, v213
    v_cvt_pk_bf16_f32 v11, v214, v215
    v_cvt_pk_bf16_f32 v12, v216, v217
    v_cvt_pk_bf16_f32 v13, v218, v219
    v_cvt_pk_bf16_f32 v14, v220, v221
    v_cvt_pk_bf16_f32 v15, v222, v223
    v_cvt_pk_bf16_f32 v16, v224, v225
    v_cvt_pk_bf16_f32 v17, v226, v227
    v_cvt_pk_bf16_f32 v18, v228, v229
    v_cvt_pk_bf16_f32 v19, v230, v231
    v_cvt_pk_bf16_f32 v20, v232, v233
    v_cvt_pk_bf16_f32 v21, v234, v235
    v_cvt_pk_bf16_f32 v22, v236, v237
    v_cvt_pk_bf16_f32 v23, v238, v239
    s_nop 1
    s_waitcnt lgkmcnt(4)
    v_mfma_f32_32x32x16_bf16 v[176:191], v[240:243], v[8:11], v[176:191]
    ds_read_b64_tr_b16 v[240:241], v6 offset:2368
    ds_read_b64_tr_b16 v[242:243], v6 offset:3520
    v_add_f32 v208, v208, v209
    v_add_f32 v210, v210, v211
    v_add_f32 v212, v212, v213
    v_add_f32 v214, v214, v215
    s_waitcnt lgkmcnt(4)
    v_mfma_f32_32x32x16_bf16 v[192:207], v[244:247], v[8:11], v[192:207]
    ds_read_b64_tr_b16 v[244:245], v6 offset:4608
    ds_read_b64_tr_b16 v[246:247], v6 offset:5760
    v_add_f32 v216, v216, v217
    v_add_f32 v218, v218, v219
    v_add_f32 v220, v220, v221
    v_add_f32 v222, v222, v223
    s_waitcnt lgkmcnt(4)
    v_mfma_f32_32x32x16_bf16 v[176:191], v[248:251], v[12:15], v[176:191]
    ds_read_b64_tr_b16 v[248:249], v6 offset:4672
    ds_read_b64_tr_b16 v[250:251], v6 offset:5824
    v_add_f32 v224, v224, v225
    v_add_f32 v226, v226, v227
    v_add_f32 v228, v228, v229
    v_add_f32 v230, v230, v231
    s_waitcnt lgkmcnt(4)
    v_mfma_f32_32x32x16_bf16 v[192:207], v[240:243], v[12:15], v[192:207]
    ds_read_b64_tr_b16 v[240:241], v6 offset:6912
    ds_read_b64_tr_b16 v[242:243], v6 offset:8064
    v_add_f32 v232, v232, v233
    v_add_f32 v234, v234, v235
    v_add_f32 v236, v236, v237
    v_add_f32 v238, v238, v239
    s_waitcnt lgkmcnt(4)
    v_mfma_f32_32x32x16_bf16 v[176:191], v[244:247], v[16:19], v[176:191]
    ds_read_b64_tr_b16 v[244:245], v6 offset:6976
    ds_read_b64_tr_b16 v[246:247], v6 offset:8128
    v_add_f32 v208, v208, v210
    v_add_f32 v212, v212, v214
    v_add_f32 v216, v216, v218
    v_add_f32 v220, v220, v222
    s_waitcnt lgkmcnt(4)
    v_mfma_f32_32x32x16_bf16 v[192:207], v[248:251], v[16:19], v[192:207]
    v_add_f32 v224, v224, v226
    v_add_f32 v228, v228, v230
    v_add_f32 v232, v232, v234
    v_add_f32 v236, v236, v238
    s_waitcnt lgkmcnt(2)
    v_mfma_f32_32x32x16_bf16 v[176:191], v[240:243], v[20:23], v[176:191]
    v_add_f32 v208, v208, v212
    v_add_f32 v216, v216, v220
    v_add_f32 v224, v224, v228
    v_add_f32 v232, v232, v236
    s_waitcnt lgkmcnt(0)
    v_mfma_f32_32x32x16_bf16 v[192:207], v[244:247], v[20:23], v[192:207]
    v_add_f32 v208, v208, v216
    v_add_f32 v224, v224, v232
    v_add_f32 v208, v208, v224
    v_add_f32 v252, v252, v208
    ds_write_b128 v3, v[128:131] offset:0
    ds_write_b128 v3, v[132:135] offset:1152
    ds_write_b128 v3, v[136:139] offset:2304
    ds_write_b128 v3, v[140:143] offset:3456
    ds_write_b128 v3, v[144:147] offset:4608
    ds_write_b128 v3, v[148:151] offset:5760
    ds_write_b128 v3, v[152:155] offset:6912
    ds_write_b128 v3, v[156:159] offset:8064
    s_waitcnt lgkmcnt(0)
    ds_read_b128 v[8:11], v24 offset:0
    ds_read_b128 v[12:15], v24 offset:32
    ds_read_b128 v[16:19], v24 offset:64
    ds_read_b128 v[20:23], v24 offset:96
    s_waitcnt lgkmcnt(3)
    v_mfma_f32_32x32x16_bf16 v[208:223], v[8:11], v[160:163], 0
    s_waitcnt lgkmcnt(2)
    v_mfma_f32_32x32x16_bf16 v[208:223], v[12:15], v[164:167], v[208:223]
    s_waitcnt lgkmcnt(1)
    v_mfma_f32_32x32x16_bf16 v[208:223], v[16:19], v[168:171], v[208:223]
    s_waitcnt lgkmcnt(0)
    v_mfma_f32_32x32x16_bf16 v[208:223], v[20:23], v[172:175], v[208:223]
    ds_read_b128 v[8:11], v24 offset:4608
    ds_read_b128 v[12:15], v24 offset:4640
    ds_read_b128 v[16:19], v24 offset:4672
    ds_read_b128 v[20:23], v24 offset:4704
    s_waitcnt lgkmcnt(3)
    v_mfma_f32_32x32x16_bf16 v[224:239], v[8:11], v[160:163], 0
    s_waitcnt lgkmcnt(2)
    v_mfma_f32_32x32x16_bf16 v[224:239], v[12:15], v[164:167], v[224:239]
    s_waitcnt lgkmcnt(1)
    v_mfma_f32_32x32x16_bf16 v[224:239], v[16:19], v[168:171], v[224:239]
    s_waitcnt lgkmcnt(0)
    v_mfma_f32_32x32x16_bf16 v[224:239], v[20:23], v[172:175], v[224:239]
    s_nop 7
    ds_write_b128 v4, v[208:211] offset:0
    ds_write_b128 v4, v[212:215] offset:1024
    ds_write_b128 v4, v[216:219] offset:2048
    ds_write_b128 v4, v[220:223] offset:3072
    s_nop 3
    ds_write_b128 v4, v[224:227] offset:4096
    ds_write_b128 v4, v[228:231] offset:5120
    ds_write_b128 v4, v[232:235] offset:6144
    ds_write_b128 v4, v[236:239] offset:7168
    s_waitcnt lgkmcnt(0)
    s_barrier
    ds_read_b64 v[208:209], v255 offset:0
    ds_read_b64 v[210:211], v255 offset:8192
    ds_read_b64 v[212:213], v255 offset:16384
    ds_read_b64 v[214:215], v255 offset:24576
    ds_read_b64 v[216:217], v255 offset:32768
    ds_read_b64 v[218:219], v255 offset:40960
    ds_read_b64 v[220:221], v255 offset:49152
    ds_read_b64 v[222:223], v255 offset:57344
    ds_read_b64 v[224:225], v255 offset:4096
    ds_read_b64 v[226:227], v255 offset:12288
    ds_read_b64 v[228:229], v255 offset:20480
    ds_read_b64 v[230:231], v255 offset:28672
    ds_read_b64 v[232:233], v255 offset:36864
    ds_read_b64 v[234:235], v255 offset:45056
    ds_read_b64 v[236:237], v255 offset:53248
    ds_read_b64 v[238:239], v255 offset:61440
    s_waitcnt lgkmcnt(14)
    v_add_f32 v208, v208, v210
    v_add_f32 v209, v209, v211
    s_waitcnt lgkmcnt(13)
    v_add_f32 v208, v208, v212
    v_add_f32 v209, v209, v213
    s_waitcnt lgkmcnt(12)
    v_add_f32 v208, v208, v214
    v_add_f32 v209, v209, v215
    s_waitcnt lgkmcnt(11)
    v_add_f32 v208, v208, v216
    v_add_f32 v209, v209, v217
    s_waitcnt lgkmcnt(10)
    v_add_f32 v208, v208, v218
    v_add_f32 v209, v209, v219
    s_waitcnt lgkmcnt(9)
    v_add_f32 v208, v208, v220
    v_add_f32 v209, v209, v221
    s_waitcnt lgkmcnt(8)
    v_add_f32 v208, v208, v222
    v_add_f32 v209, v209, v223
    s_waitcnt lgkmcnt(6)
    v_add_f32 v224, v224, v226
    v_add_f32 v225, v225, v227
    s_waitcnt lgkmcnt(5)
    v_add_f32 v224, v224, v228
    v_add_f32 v225, v225, v229
    s_waitcnt lgkmcnt(4)
    v_add_f32 v224, v224, v230
    v_add_f32 v225, v225, v231
    s_waitcnt lgkmcnt(3)
    v_add_f32 v224, v224, v232
    v_add_f32 v225, v225, v233
    s_waitcnt lgkmcnt(2)
    v_add_f32 v224, v224, v234
    v_add_f32 v225, v225, v235
    s_waitcnt lgkmcnt(1)
    v_add_f32 v224, v224, v236
    v_add_f32 v225, v225, v237
    s_waitcnt lgkmcnt(0)
    v_add_f32 v224, v224, v238
    v_add_f32 v225, v225, v239
    ds_write_b64 v25, v[208:209]
    ds_write_b64 v25, v[224:225] offset:4096
    s_waitcnt lgkmcnt(0)
    s_barrier
    ds_read_b128 v[208:211], v5 offset:0
    ds_read_b128 v[212:215], v5 offset:1024
    ds_read_b128 v[216:219], v5 offset:2048
    ds_read_b128 v[220:223], v5 offset:3072
    ds_read_b128 v[224:227], v5 offset:4096
    ds_read_b128 v[228:231], v5 offset:5120
    ds_read_b128 v[232:235], v5 offset:6144
    ds_read_b128 v[236:239], v5 offset:7168
    ds_read_b64_tr_b16 v[240:241], v6 offset:0
    ds_read_b64_tr_b16 v[242:243], v6 offset:1152
    ds_read_b64_tr_b16 v[244:245], v6 offset:64
    ds_read_b64_tr_b16 v[246:247], v6 offset:1216
    ds_read_b64_tr_b16 v[248:249], v6 offset:2304
    ds_read_b64_tr_b16 v[250:251], v6 offset:3456
    s_waitcnt lgkmcnt(6)
    v_max3_f32 v254, v208, v209, v210
    v_max3_f32 v254, v254, v211, v212
    v_max3_f32 v254, v254, v213, v214
    v_max3_f32 v254, v254, v215, v216
    v_max3_f32 v254, v254, v217, v218
    v_max3_f32 v254, v254, v219, v220
    v_max3_f32 v254, v254, v221, v222
    v_max3_f32 v254, v254, v223, v224
    v_max3_f32 v254, v254, v225, v226
    v_max3_f32 v254, v254, v227, v228
    v_max3_f32 v254, v254, v229, v230
    v_max3_f32 v254, v254, v231, v232
    v_max3_f32 v254, v254, v233, v234
    v_max3_f32 v254, v254, v235, v236
    v_max3_f32 v254, v254, v237, v238
    v_max_f32 v254, v254, v239
    v_cmp_gt_f32 vcc, v254, v7
    s_cbranch_vccnz L_arare_19
L_aback_20:
    v_fma_f32 v208, v208, s65, v253
    v_fma_f32 v209, v209, s65, v253
    v_fma_f32 v210, v210, s65, v253
    v_fma_f32 v211, v211, s65, v253
    v_fma_f32 v212, v212, s65, v253
    v_fma_f32 v213, v213, s65, v253
    v_fma_f32 v214, v214, s65, v253
    v_fma_f32 v215, v215, s65, v253
    v_fma_f32 v216, v216, s65, v253
    v_fma_f32 v217, v217, s65, v253
    v_fma_f32 v218, v218, s65, v253
    v_fma_f32 v219, v219, s65, v253
    v_fma_f32 v220, v220, s65, v253
    v_fma_f32 v221, v221, s65, v253
    v_fma_f32 v222, v222, s65, v253
    v_fma_f32 v223, v223, s65, v253
    v_fma_f32 v224, v224, s65, v253
    v_fma_f32 v225, v225, s65, v253
    v_fma_f32 v226, v226, s65, v253
    v_fma_f32 v227, v227, s65, v253
    v_fma_f32 v228, v228, s65, v253
    v_fma_f32 v229, v229, s65, v253
    v_fma_f32 v230, v230, s65, v253
    v_fma_f32 v231, v231, s65, v253
    v_fma_f32 v232, v232, s65, v253
    v_fma_f32 v233, v233, s65, v253
    v_fma_f32 v234, v234, s65, v253
    v_fma_f32 v235, v235, s65, v253
    v_fma_f32 v236, v236, s65, v253
    v_fma_f32 v237, v237, s65, v253
    v_fma_f32 v238, v238, s65, v253
    v_fma_f32 v239, v239, s65, v253
    v_exp_f32 v208, v208
    v_exp_f32 v209, v209
    v_exp_f32 v210, v210
    v_exp_f32 v211, v211
    v_exp_f32 v212, v212
    v_exp_f32 v213, v213
    v_exp_f32 v214, v214
    v_exp_f32 v215, v215
    v_exp_f32 v216, v216
    v_exp_f32 v217, v217
    v_exp_f32 v218, v218
    v_exp_f32 v219, v219
    v_exp_f32 v220, v220
    v_exp_f32 v221, v221
    v_exp_f32 v222, v222
    v_exp_f32 v223, v223
    v_exp_f32 v224, v224
    v_exp_f32 v225, v225
    v_exp_f32 v226, v226
    v_exp_f32 v227, v227
    v_exp_f32 v228, v228
    v_exp_f32 v229, v229
    v_exp_f32 v230, v230
    v_exp_f32 v231, v231
    v_exp_f32 v232, v232
    v_exp_f32 v233, v233
    v_exp_f32 v234, v234
    v_exp_f32 v235, v235
    v_exp_f32 v236, v236
    v_exp_f32 v237, v237
    v_exp_f32 v238, v238
    v_exp_f32 v239, v239
    s_nop 0
    v_cvt_pk_bf16_f32 v8, v208, v209
    v_cvt_pk_bf16_f32 v9, v210, v211
    v_cvt_pk_bf16_f32 v10, v212, v213
    v_cvt_pk_bf16_f32 v11, v214, v215
    v_cvt_pk_bf16_f32 v12, v216, v217
    v_cvt_pk_bf16_f32 v13, v218, v219
    v_cvt_pk_bf16_f32 v14, v220, v221
    v_cvt_pk_bf16_f32 v15, v222, v223
    v_cvt_pk_bf16_f32 v16, v224, v225
    v_cvt_pk_bf16_f32 v17, v226, v227
    v_cvt_pk_bf16_f32 v18, v228, v229
    v_cvt_pk_bf16_f32 v19, v230, v231
    v_cvt_pk_bf16_f32 v20, v232, v233
    v_cvt_pk_bf16_f32 v21, v234, v235
    v_cvt_pk_bf16_f32 v22, v236, v237
    v_cvt_pk_bf16_f32 v23, v238, v239
    s_nop 1
    s_waitcnt lgkmcnt(4)
    v_mfma_f32_32x32x16_bf16 v[176:191], v[240:243], v[8:11], v[176:191]
    ds_read_b64_tr_b16 v[240:241], v6 offset:2368
    ds_read_b64_tr_b16 v[242:243], v6 offset:3520
    v_add_f32 v208, v208, v209
    v_add_f32 v210, v210, v211
    v_add_f32 v212, v212, v213
    v_add_f32 v214, v214, v215
    s_waitcnt lgkmcnt(4)
    v_mfma_f32_32x32x16_bf16 v[192:207], v[244:247], v[8:11], v[192:207]
    ds_read_b64_tr_b16 v[244:245], v6 offset:4608
    ds_read_b64_tr_b16 v[246:247], v6 offset:5760
    v_add_f32 v216, v216, v217
    v_add_f32 v218, v218, v219
    v_add_f32 v220, v220, v221
    v_add_f32 v222, v222, v223
    s_waitcnt lgkmcnt(4)
    v_mfma_f32_32x32x16_bf16 v[176:191], v[248:251], v[12:15], v[176:191]
    ds_read_b64_tr_b16 v[248:249], v6 offset:4672
    ds_read_b64_tr_b16 v[250:251], v6 offset:5824
    v_add_f32 v224, v224, v225
    v_add_f32 v226, v226, v227
    v_add_f32 v228, v228, v229
    v_add_f32 v230, v230, v231
    s_waitcnt lgkmcnt(4)
    v_mfma_f32_32x32x16_bf16 v[192:207], v[240:243], v[12:15], v[192:207]
    ds_read_b64_tr_b16 v[240:241], v6 offset:6912
    ds_read_b64_tr_b16 v[242:243], v6 offset:8064
    v_add_f32 v232, v232, v233
    v_add_f32 v234, v234, v235
    v_add_f32 v236, v236, v237
    v_add_f32 v238, v238, v239
    s_waitcnt lgkmcnt(4)
    v_mfma_f32_32x32x16_bf16 v[176:191], v[244:247], v[16:19], v[176:191]
    ds_read_b64_tr_b16 v[244:245], v6 offset:6976
    ds_read_b64_tr_b16 v[246:247], v6 offset:8128
    v_add_f32 v208, v208, v210
    v_add_f32 v212, v212, v214
    v_add_f32 v216, v216, v218
    v_add_f32 v220, v220, v222
    s_waitcnt lgkmcnt(4)
    v_mfma_f32_32x32x16_bf16 v[192:207], v[248:251], v[16:19], v[192:207]
    v_add_f32 v224, v224, v226
    v_add_f32 v228, v228, v230
    v_add_f32 v232, v232, v234
    v_add_f32 v236, v236, v238
    s_waitcnt lgkmcnt(2)
    v_mfma_f32_32x32x16_bf16 v[176:191], v[240:243], v[20:23], v[176:191]
    v_add_f32 v208, v208, v212
    v_add_f32 v216, v216, v220
    v_add_f32 v224, v224, v228
    v_add_f32 v232, v232, v236
    s_waitcnt lgkmcnt(0)
    v_mfma_f32_32x32x16_bf16 v[192:207], v[244:247], v[20:23], v[192:207]
    v_add_f32 v208, v208, v216
    v_add_f32 v224, v224, v232
    v_add_f32 v208, v208, v224
    v_add_f32 v252, v252, v208
    s_branch L_adone_21
L_arare_13:
    v_mov_b32 v8, v254
    v_mov_b32 v9, v254
    s_nop 1
    v_permlane32_swap_b32 v8, v9
    s_nop 1
    v_max3_f32 v254, v8, v9, v7
    v_sub_f32 v8, v7, v254
    v_mul_f32 v8, s65, v8
    v_exp_f32 v8, v8
    v_mov_b32 v7, v254
    v_mul_f32 v253, s65, v254
    v_sub_f32 v253, 0, v253
    v_mul_f32 v252, v252, v8
    v_mul_f32 v176, v176, v8
    v_mul_f32 v177, v177, v8
    v_mul_f32 v178, v178, v8
    v_mul_f32 v179, v179, v8
    v_mul_f32 v180, v180, v8
    v_mul_f32 v181, v181, v8
    v_mul_f32 v182, v182, v8
    v_mul_f32 v183, v183, v8
    v_mul_f32 v184, v184, v8
    v_mul_f32 v185, v185, v8
    v_mul_f32 v186, v186, v8
    v_mul_f32 v187, v187, v8
    v_mul_f32 v188, v188, v8
    v_mul_f32 v189, v189, v8
    v_mul_f32 v190, v190, v8
    v_mul_f32 v191, v191, v8
    v_mul_f32 v192, v192, v8
    v_mul_f32 v193, v193, v8
    v_mul_f32 v194, v194, v8
    v_mul_f32 v195, v195, v8
    v_mul_f32 v196, v196, v8
    v_mul_f32 v197, v197, v8
    v_mul_f32 v198, v198, v8
    v_mul_f32 v199, v199, v8
    v_mul_f32 v200, v200, v8
    v_mul_f32 v201, v201, v8
    v_mul_f32 v202, v202, v8
    v_mul_f32 v203, v203, v8
    v_mul_f32 v204, v204, v8
    v_mul_f32 v205, v205, v8
    v_mul_f32 v206, v206, v8
    v_mul_f32 v207, v207, v8
    s_branch L_aback_14
L_arare_15:
    v_mov_b32 v8, v254
    v_mov_b32 v9, v254
    s_nop 1
    v_permlane32_swap_b32 v8, v9
    s_nop 1
    v_max3_f32 v254, v8, v9, v7
    v_sub_f32 v8, v7, v254
    v_mul_f32 v8, s65, v8
    v_exp_f32 v8, v8
    v_mov_b32 v7, v254
    v_mul_f32 v253, s65, v254
    v_sub_f32 v253, 0, v253
    v_mul_f32 v252, v252, v8
    v_mul_f32 v176, v176, v8
    v_mul_f32 v177, v177, v8
    v_mul_f32 v178, v178, v8
    v_mul_f32 v179, v179, v8
    v_mul_f32 v180, v180, v8
    v_mul_f32 v181, v181, v8
    v_mul_f32 v182, v182, v8
    v_mul_f32 v183, v183, v8
    v_mul_f32 v184, v184, v8
    v_mul_f32 v185, v185, v8
    v_mul_f32 v186, v186, v8
    v_mul_f32 v187, v187, v8
    v_mul_f32 v188, v188, v8
    v_mul_f32 v189, v189, v8
    v_mul_f32 v190, v190, v8
    v_mul_f32 v191, v191, v8
    v_mul_f32 v192, v192, v8
    v_mul_f32 v193, v193, v8
    v_mul_f32 v194, v194, v8
    v_mul_f32 v195, v195, v8
    v_mul_f32 v196, v196, v8
    v_mul_f32 v197, v197, v8
    v_mul_f32 v198, v198, v8
    v_mul_f32 v199, v199, v8
    v_mul_f32 v200, v200, v8
    v_mul_f32 v201, v201, v8
    v_mul_f32 v202, v202, v8
    v_mul_f32 v203, v203, v8
    v_mul_f32 v204, v204, v8
    v_mul_f32 v205, v205, v8
    v_mul_f32 v206, v206, v8
    v_mul_f32 v207, v207, v8
    s_branch L_aback_16
L_arare_17:
    v_mov_b32 v8, v254
    v_mov_b32 v9, v254
    s_nop 1
    v_permlane32_swap_b32 v8, v9
    s_nop 1
    v_max3_f32 v254, v8, v9, v7
    v_sub_f32 v8, v7, v254
    v_mul_f32 v8, s65, v8
    v_exp_f32 v8, v8
    v_mov_b32 v7, v254
    v_mul_f32 v253, s65, v254
    v_sub_f32 v253, 0, v253
    v_mul_f32 v252, v252, v8
    v_mul_f32 v176, v176, v8
    v_mul_f32 v177, v177, v8
    v_mul_f32 v178, v178, v8
    v_mul_f32 v179, v179, v8
    v_mul_f32 v180, v180, v8
    v_mul_f32 v181, v181, v8
    v_mul_f32 v182, v182, v8
    v_mul_f32 v183, v183, v8
    v_mul_f32 v184, v184, v8
    v_mul_f32 v185, v185, v8
    v_mul_f32 v186, v186, v8
    v_mul_f32 v187, v187, v8
    v_mul_f32 v188, v188, v8
    v_mul_f32 v189, v189, v8
    v_mul_f32 v190, v190, v8
    v_mul_f32 v191, v191, v8
    v_mul_f32 v192, v192, v8
    v_mul_f32 v193, v193, v8
    v_mul_f32 v194, v194, v8
    v_mul_f32 v195, v195, v8
    v_mul_f32 v196, v196, v8
    v_mul_f32 v197, v197, v8
    v_mul_f32 v198, v198, v8
    v_mul_f32 v199, v199, v8
    v_mul_f32 v200, v200, v8
    v_mul_f32 v201, v201, v8
    v_mul_f32 v202, v202, v8
    v_mul_f32 v203, v203, v8
    v_mul_f32 v204, v204, v8
    v_mul_f32 v205, v205, v8
    v_mul_f32 v206, v206, v8
    v_mul_f32 v207, v207, v8
    s_branch L_aback_18
L_arare_19:
    v_mov_b32 v8, v254
    v_mov_b32 v9, v254
    s_nop 1
    v_permlane32_swap_b32 v8, v9
    s_nop 1
    v_max3_f32 v254, v8, v9, v7
    v_sub_f32 v8, v7, v254
    v_mul_f32 v8, s65, v8
    v_exp_f32 v8, v8
    v_mov_b32 v7, v254
    v_mul_f32 v253, s65, v254
    v_sub_f32 v253, 0, v253
    v_mul_f32 v252, v252, v8
    v_mul_f32 v176, v176, v8
    v_mul_f32 v177, v177, v8
    v_mul_f32 v178, v178, v8
    v_mul_f32 v179, v179, v8
    v_mul_f32 v180, v180, v8
    v_mul_f32 v181, v181, v8
    v_mul_f32 v182, v182, v8
    v_mul_f32 v183, v183, v8
    v_mul_f32 v184, v184, v8
    v_mul_f32 v185, v185, v8
    v_mul_f32 v186, v186, v8
    v_mul_f32 v187, v187, v8
    v_mul_f32 v188, v188, v8
    v_mul_f32 v189, v189, v8
    v_mul_f32 v190, v190, v8
    v_mul_f32 v191, v191, v8
    v_mul_f32 v192, v192, v8
    v_mul_f32 v193, v193, v8
    v_mul_f32 v194, v194, v8
    v_mul_f32 v195, v195, v8
    v_mul_f32 v196, v196, v8
    v_mul_f32 v197, v197, v8
    v_mul_f32 v198, v198, v8
    v_mul_f32 v199, v199, v8
    v_mul_f32 v200, v200, v8
    v_mul_f32 v201, v201, v8
    v_mul_f32 v202, v202, v8
    v_mul_f32 v203, v203, v8
    v_mul_f32 v204, v204, v8
    v_mul_f32 v205, v205, v8
    v_mul_f32 v206, v206, v8
    v_mul_f32 v207, v207, v8
    s_branch L_aback_20
L_adone_21:
    s_lshl_b32 s66, s2, 15
    s_add_u32 s76, s66, 65536
    s_add_u32 s52, s42, s76
    s_addc_u32 s53, s43, 0
    s_mov_b32 s54, 0x8000
    s_mov_b32 s55, 0x00020000
    s_lshl_b32 s66, s73, 13
    s_lshl_b32 s67, s74, 3
    s_add_u32 s66, s66, s67
    s_add_u32 s76, s66, 4259840
    s_add_u32 s56, s42, s76
    s_addc_u32 s57, s43, 0
    s_mov_b32 s58, 0x1f08
    s_mov_b32 s59, 0x00020000
    s_mul_i32 s66, s64, 9216
    s_add_u32 s66, s66, 73728
    v_and_b32 v240, 31, v1
    v_lshrrev_b32 v241, 5, v1
    v_mul_u32_u24 v242, 272, v240
    v_lshlrev_b32 v241, 4, v241
    v_add_u32 v242, v242, v241
    v_add_u32 v242, s66, v242
    v_lshrrev_b32 v243, 3, v1
    v_and_b32 v244, 7, v1
    v_mul_u32_u24 v245, 272, v243
    v_lshlrev_b32 v247, 5, v244
    v_add_u32 v245, v245, v247
    v_add_u32 v245, s66, v245
    v_lshlrev_b32 v246, 10, v243
    v_lshlrev_b32 v247, 4, v244
    v_add_u32 v246, v246, v247
    s_lshl_b32 s66, s64, 7
    v_add_u32 v246, s66, v246
    s_nop 7
    s_nop 3
    ds_write_b128 v242, v[176:179] offset:0
    ds_write_b128 v242, v[180:183] offset:32
    ds_write_b128 v242, v[184:187] offset:64
    ds_write_b128 v242, v[188:191] offset:96
    ds_write_b128 v242, v[192:195] offset:128
    ds_write_b128 v242, v[196:199] offset:160
    ds_write_b128 v242, v[200:203] offset:192
    ds_write_b128 v242, v[204:207] offset:224
    s_waitcnt lgkmcnt(0)
    ds_read_b128 v[176:179], v245 offset:0
    ds_read_b128 v[180:183], v245 offset:16
    ds_read_b128 v[184:187], v245 offset:2176
    ds_read_b128 v[188:191], v245 offset:2192
    ds_read_b128 v[192:195], v245 offset:4352
    ds_read_b128 v[196:199], v245 offset:4368
    ds_read_b128 v[200:203], v245 offset:6528
    ds_read_b128 v[204:207], v245 offset:6544
    s_mov_b32 s66, 0
    s_waitcnt lgkmcnt(6)
    v_cvt_pk_bf16_f32 v208, v176, v177
    v_cvt_pk_bf16_f32 v209, v178, v179
    v_cvt_pk_bf16_f32 v210, v180, v181
    v_cvt_pk_bf16_f32 v211, v182, v183
    buffer_store_dwordx4 v[208:211], v246, s[52:55], s66 offen sc1
    s_add_u32 s66, s66, 8192
    s_waitcnt lgkmcnt(4)
    v_cvt_pk_bf16_f32 v212, v184, v185
    v_cvt_pk_bf16_f32 v213, v186, v187
    v_cvt_pk_bf16_f32 v214, v188, v189
    v_cvt_pk_bf16_f32 v215, v190, v191
    buffer_store_dwordx4 v[212:215], v246, s[52:55], s66 offen sc1
    s_add_u32 s66, s66, 8192
    s_waitcnt lgkmcnt(2)
    v_cvt_pk_bf16_f32 v216, v192, v193
    v_cvt_pk_bf16_f32 v217, v194, v195
    v_cvt_pk_bf16_f32 v218, v196, v197
    v_cvt_pk_bf16_f32 v219, v198, v199
    buffer_store_dwordx4 v[216:219], v246, s[52:55], s66 offen sc1
    s_add_u32 s66, s66, 8192
    s_waitcnt lgkmcnt(0)
    v_cvt_pk_bf16_f32 v220, v200, v201
    v_cvt_pk_bf16_f32 v221, v202, v203
    v_cvt_pk_bf16_f32 v222, v204, v205
    v_cvt_pk_bf16_f32 v223, v206, v207
    buffer_store_dwordx4 v[220:223], v246, s[52:55], s66 offen sc1
    v_mov_b32 v248, v252
    v_mov_b32 v249, v252
    s_nop 1
    v_permlane32_swap_b32 v248, v249
    s_nop 1
    v_add_f32 v251, v248, v249
    v_mov_b32 v250, v7
    v_lshlrev_b32 v243, 8, v0
    buffer_store_dwordx2 v[250:251], v243, s[56:59], 0 offen sc1
    s_waitcnt vmcnt(0) lgkmcnt(0)
    s_barrier
    s_cmp_lg_u32 s64, 0
    s_cbranch_scc1 L_arr_skip_22
    v_mov_b32 v8, 1
    v_mov_b32 v9, 0
    s_mov_b64 exec, 1
    buffer_atomic_add v8, v9, s[84:87], 0 offen offset:128
    s_mov_b64 exec, -1
L_arr_skip_22:
    v_and_b32 v1, 63, v0
    v_lshrrev_b32 v8, 6, v0
    v_and_b32 v2, 15, v1
    v_readfirstlane_b32 s64, v8
    v_lshrrev_b32 v3, 4, v1
    s_mov_b32 s65, 0x3e0293ee
    v_and_b32 v8, 7, v1
    v_lshrrev_b32 v9, 1, v8
    v_and_b32 v8, 1, v8
    v_lshlrev_b32 v8, 4, v8
    v_mov_b32 v10, 0xffff
    v_lshlrev_b32 v10, v8, v10
    v_cmp_eq_u32 vcc, 0, v9
    s_nop 1
    v_cndmask_b32 v4, 0, v10, vcc
    v_cmp_eq_u32 vcc, 1, v9
    s_nop 1
    v_cndmask_b32 v5, 0, v10, vcc
    v_cmp_eq_u32 vcc, 2, v9
    s_nop 1
    v_cndmask_b32 v6, 0, v10, vcc
    v_cmp_eq_u32 vcc, 3, v9
    s_nop 1
    v_cndmask_b32 v7, 0, v10, vcc
    s_and_b32 s72, s2, 31
    s_lshr_b32 s73, s2, 5
    s_lshl_b32 s76, s72, 8
    s_add_u32 s52, s24, s76
    s_addc_u32 s53, s25, 0
    s_mov_b32 s54, 0x0
    s_mov_b32 s55, 0x00020000
    s_sub_u32 s54, 4194304, s76
    s_lshl_b32 s76, s72, 17
    s_add_u32 s56, s26, s76
    s_addc_u32 s57, s27, 0
    s_mov_b32 s58, 0x20000
    s_mov_b32 s59, 0x00020000
    v_lshlrev_b32 v9, 17, v3
    v_lshlrev_b32 v10, 4, v2
    v_add_u32 v9, v9, v10
    s_lshl_b32 s66, s64, 19
    buffer_load_dwordx4 v[128:131], v9, s[52:55], s66 offen
    s_add_u32 s66, s66, 8192
    buffer_load_dwordx4 v[132:135], v9, s[52:55], s66 offen
    s_add_u32 s66, s66, 8192
    buffer_load_dwordx4 v[136:139], v9, s[52:55], s66 offen
    s_add_u32 s66, s66, 8192
    buffer_load_dwordx4 v[140:143], v9, s[52:55], s66 offen
    s_add_u32 s66, s66, 8192
    buffer_load_dwordx4 v[144:147], v9, s[52:55], s66 offen
    s_add_u32 s66, s66, 8192
    buffer_load_dwordx4 v[148:151], v9, s[52:55], s66 offen
    s_add_u32 s66, s66, 8192
    buffer_load_dwordx4 v[152:155], v9, s[52:55], s66 offen
    s_add_u32 s66, s66, 8192
    buffer_load_dwordx4 v[156:159], v9, s[52:55], s66 offen
    s_add_u32 s66, s66, 8192
    buffer_load_dwordx4 v[160:163], v9, s[52:55], s66 offen
    s_add_u32 s66, s66, 8192
    buffer_load_dwordx4 v[164:167], v9, s[52:55], s66 offen
    s_add_u32 s66, s66, 8192
    buffer_load_dwordx4 v[168:171], v9, s[52:55], s66 offen
    s_add_u32 s66, s66, 8192
    buffer_load_dwordx4 v[172:175], v9, s[52:55], s66 offen
    s_add_u32 s66, s66, 8192
    buffer_load_dwordx4 v[176:179], v9, s[52:55], s66 offen
    s_add_u32 s66, s66, 8192
    buffer_load_dwordx4 v[180:183], v9, s[52:55], s66 offen
    s_add_u32 s66, s66, 8192
    buffer_load_dwordx4 v[184:187], v9, s[52:55], s66 offen
    s_add_u32 s66, s66, 8192
    buffer_load_dwordx4 v[188:191], v9, s[52:55], s66 offen
    s_and_b32 s67, s64, 3
    s_lshr_b32 s68, s64, 2
    v_lshlrev_b32 v31, 14, v3
    v_lshlrev_b32 v10, 4, v2
    v_add_u32 v31, v31, v10
    s_lshl_b32 s88, s68, 16
    s_lshl_b32 s69, s67, 8
    s_add_u32 s88, s88, s69
    s_add_u32 s89, s88, 4096
    s_add_u32 s90, s88, 8192
    s_add_u32 s91, s88, 12288
    buffer_load_dwordx4 v[192:195], v31, s[56:59], s88 offen offset:0
    buffer_load_dwordx4 v[196:199], v31, s[56:59], s88 offen offset:1024
    buffer_load_dwordx4 v[200:203], v31, s[56:59], s88 offen offset:2048
    buffer_load_dwordx4 v[204:207], v31, s[56:59], s88 offen offset:3072
    buffer_load_dwordx4 v[208:211], v31, s[56:59], s89 offen offset:0
    buffer_load_dwordx4 v[212:215], v31, s[56:59], s89 offen offset:1024
    buffer_load_dwordx4 v[216:219], v31, s[56:59], s89 offen offset:2048
    buffer_load_dwordx4 v[220:223], v31, s[56:59], s89 offen offset:3072
    buffer_load_dwordx4 v[224:227], v31, s[56:59], s90 offen offset:0
    buffer_load_dwordx4 v[228:231], v31, s[56:59], s90 offen offset:1024
    buffer_load_dwordx4 v[232:235], v31, s[56:59], s90 offen offset:2048
    buffer_load_dwordx4 v[236:239], v31, s[56:59], s90 offen offset:3072
    buffer_load_dwordx4 v[240:243], v31, s[56:59], s91 offen offset:0
    buffer_load_dwordx4 v[244:247], v31, s[56:59], s91 offen offset:1024
    buffer_load_dwordx4 v[248:251], v31, s[56:59], s91 offen offset:2048
    buffer_load_dwordx4 v[252:255], v31, s[56:59], s91 offen offset:3072
    s_cmp_lg_u32 s64, 0
    s_cbranch_scc1 L_sync_skip_23
    v_mov_b32 v9, 0
    s_mov_b32 s71, 0
L_sync_poll_24:
    buffer_load_dword v8, v9, s[84:87], 0 offen offset:128 sc1
    s_add_u32 s71, s71, 1
    s_waitcnt vmcnt(0)
    v_readfirstlane_b32 s70, v8
    s_cmp_ge_u32 s71, 0x40000
    s_cbranch_scc1 L_sync_done_25
    s_cmp_ge_u32 s70, 64
    s_cbranch_scc1 L_sync_done_25
    s_sleep 1
    s_branch L_sync_poll_24
L_sync_done_25:
L_sync_skip_23:
    s_barrier
    s_lshl_b32 s66, s73, 20
    s_lshl_b32 s67, s72, 10
    s_add_u32 s66, s66, s67
    s_add_u32 s76, s66, 65536
    s_add_u32 s44, s42, s76
    s_addc_u32 s45, s43, 0
    s_mov_b32 s46, 0xf8400
    s_mov_b32 s47, 0x00020000
    s_lshl_b32 s66, s73, 13
    s_lshl_b32 s67, s72, 8
    s_add_u32 s66, s66, s67
    s_add_u32 s76, s66, 4259840
    s_add_u32 s48, s42, s76
    s_addc_u32 s49, s43, 0
    s_mov_b32 s50, 0x100
    s_mov_b32 s51, 0x00020000
    s_lshl_b32 s66, s72, 12
    s_lshl_b32 s67, s73, 11
    s_add_u32 s66, s66, s67
    s_add_u32 s76, s66, 4325376
    s_add_u32 s60, s42, s76
    s_addc_u32 s61, s43, 0
    s_mov_b32 s62, 0x800
    s_mov_b32 s63, 0x00020000
    v_lshlrev_b32 v10, 4, v1
    v_mov_b32 v11, 0
    s_lshl_b32 s66, s64, 17
    buffer_load_dwordx4 v[32:35], v11, s[48:51], 0 offen offset:0 sc1
    buffer_load_dwordx4 v[36:39], v11, s[48:51], 0 offen offset:16 sc1
    buffer_load_dwordx4 v[40:43], v11, s[48:51], 0 offen offset:32 sc1
    buffer_load_dwordx4 v[44:47], v11, s[48:51], 0 offen offset:48 sc1
    buffer_load_dwordx4 v[48:51], v11, s[48:51], 0 offen offset:64 sc1
    buffer_load_dwordx4 v[52:55], v11, s[48:51], 0 offen offset:80 sc1
    buffer_load_dwordx4 v[56:59], v11, s[48:51], 0 offen offset:96 sc1
    buffer_load_dwordx4 v[60:63], v11, s[48:51], 0 offen offset:112 sc1
    buffer_load_dwordx4 v[64:67], v11, s[48:51], 0 offen offset:128 sc1
    buffer_load_dwordx4 v[68:71], v11, s[48:51], 0 offen offset:144 sc1
    buffer_load_dwordx4 v[72:75], v11, s[48:51], 0 offen offset:160 sc1
    buffer_load_dwordx4 v[76:79], v11, s[48:51], 0 offen offset:176 sc1
    buffer_load_dwordx4 v[80:83], v11, s[48:51], 0 offen offset:192 sc1
    buffer_load_dwordx4 v[84:87], v11, s[48:51], 0 offen offset:208 sc1
    buffer_load_dwordx4 v[88:91], v11, s[48:51], 0 offen offset:224 sc1
    buffer_load_dwordx4 v[92:95], v11, s[48:51], 0 offen offset:240 sc1
    buffer_load_dwordx4 v[96:99], v10, s[44:47], s66 offen sc1
    s_add_u32 s66, s66, 32768
    buffer_load_dwordx4 v[100:103], v10, s[44:47], s66 offen sc1
    s_add_u32 s66, s66, 32768
    buffer_load_dwordx4 v[104:107], v10, s[44:47], s66 offen sc1
    s_add_u32 s66, s66, 32768
    buffer_load_dwordx4 v[108:111], v10, s[44:47], s66 offen sc1
    s_waitcnt vmcnt(4)
    v_max_f32 v12, v32, v34
    v_max3_f32 v12, v12, v36, v38
    v_max3_f32 v12, v12, v40, v42
    v_max3_f32 v12, v12, v44, v46
    v_max3_f32 v12, v12, v48, v50
    v_max3_f32 v12, v12, v52, v54
    v_max3_f32 v12, v12, v56, v58
    v_max3_f32 v12, v12, v60, v62
    v_max3_f32 v12, v12, v64, v66
    v_max3_f32 v12, v12, v68, v70
    v_max3_f32 v12, v12, v72, v74
    v_max3_f32 v12, v12, v76, v78
    v_max3_f32 v12, v12, v80, v82
    v_max3_f32 v12, v12, v84, v86
    v_max3_f32 v12, v12, v88, v90
    v_max3_f32 v12, v12, v92, v94
    v_sub_f32 v32, v32, v12
    v_mul_f32 v32, s65, v32
    v_exp_f32 v32, v32
    v_sub_f32 v34, v34, v12
    v_mul_f32 v34, s65, v34
    v_exp_f32 v34, v34
    v_sub_f32 v36, v36, v12
    v_mul_f32 v36, s65, v36
    v_exp_f32 v36, v36
    v_sub_f32 v38, v38, v12
    v_mul_f32 v38, s65, v38
    v_exp_f32 v38, v38
    v_sub_f32 v40, v40, v12
    v_mul_f32 v40, s65, v40
    v_exp_f32 v40, v40
    v_sub_f32 v42, v42, v12
    v_mul_f32 v42, s65, v42
    v_exp_f32 v42, v42
    v_sub_f32 v44, v44, v12
    v_mul_f32 v44, s65, v44
    v_exp_f32 v44, v44
    v_sub_f32 v46, v46, v12
    v_mul_f32 v46, s65, v46
    v_exp_f32 v46, v46
    v_sub_f32 v48, v48, v12
    v_mul_f32 v48, s65, v48
    v_exp_f32 v48, v48
    v_sub_f32 v50, v50, v12
    v_mul_f32 v50, s65, v50
    v_exp_f32 v50, v50
    v_sub_f32 v52, v52, v12
    v_mul_f32 v52, s65, v52
    v_exp_f32 v52, v52
    v_sub_f32 v54, v54, v12
    v_mul_f32 v54, s65, v54
    v_exp_f32 v54, v54
    v_sub_f32 v56, v56, v12
    v_mul_f32 v56, s65, v56
    v_exp_f32 v56, v56
    v_sub_f32 v58, v58, v12
    v_mul_f32 v58, s65, v58
    v_exp_f32 v58, v58
    v_sub_f32 v60, v60, v12
    v_mul_f32 v60, s65, v60
    v_exp_f32 v60, v60
    v_sub_f32 v62, v62, v12
    v_mul_f32 v62, s65, v62
    v_exp_f32 v62, v62
    v_sub_f32 v64, v64, v12
    v_mul_f32 v64, s65, v64
    v_exp_f32 v64, v64
    v_sub_f32 v66, v66, v12
    v_mul_f32 v66, s65, v66
    v_exp_f32 v66, v66
    v_sub_f32 v68, v68, v12
    v_mul_f32 v68, s65, v68
    v_exp_f32 v68, v68
    v_sub_f32 v70, v70, v12
    v_mul_f32 v70, s65, v70
    v_exp_f32 v70, v70
    v_sub_f32 v72, v72, v12
    v_mul_f32 v72, s65, v72
    v_exp_f32 v72, v72
    v_sub_f32 v74, v74, v12
    v_mul_f32 v74, s65, v74
    v_exp_f32 v74, v74
    v_sub_f32 v76, v76, v12
    v_mul_f32 v76, s65, v76
    v_exp_f32 v76, v76
    v_sub_f32 v78, v78, v12
    v_mul_f32 v78, s65, v78
    v_exp_f32 v78, v78
    v_sub_f32 v80, v80, v12
    v_mul_f32 v80, s65, v80
    v_exp_f32 v80, v80
    v_sub_f32 v82, v82, v12
    v_mul_f32 v82, s65, v82
    v_exp_f32 v82, v82
    v_sub_f32 v84, v84, v12
    v_mul_f32 v84, s65, v84
    v_exp_f32 v84, v84
    v_sub_f32 v86, v86, v12
    v_mul_f32 v86, s65, v86
    v_exp_f32 v86, v86
    v_sub_f32 v88, v88, v12
    v_mul_f32 v88, s65, v88
    v_exp_f32 v88, v88
    v_sub_f32 v90, v90, v12
    v_mul_f32 v90, s65, v90
    v_exp_f32 v90, v90
    v_sub_f32 v92, v92, v12
    v_mul_f32 v92, s65, v92
    v_exp_f32 v92, v92
    v_sub_f32 v94, v94, v12
    v_mul_f32 v94, s65, v94
    v_exp_f32 v94, v94
    s_nop 0
    v_mul_f32 v13, v32, v33
    v_fmac_f32 v13, v34, v35
    v_fmac_f32 v13, v36, v37
    v_fmac_f32 v13, v38, v39
    v_fmac_f32 v13, v40, v41
    v_fmac_f32 v13, v42, v43
    v_fmac_f32 v13, v44, v45
    v_fmac_f32 v13, v46, v47
    v_fmac_f32 v13, v48, v49
    v_fmac_f32 v13, v50, v51
    v_fmac_f32 v13, v52, v53
    v_fmac_f32 v13, v54, v55
    v_fmac_f32 v13, v56, v57
    v_fmac_f32 v13, v58, v59
    v_fmac_f32 v13, v60, v61
    v_fmac_f32 v13, v62, v63
    v_fmac_f32 v13, v64, v65
    v_fmac_f32 v13, v66, v67
    v_fmac_f32 v13, v68, v69
    v_fmac_f32 v13, v70, v71
    v_fmac_f32 v13, v72, v73
    v_fmac_f32 v13, v74, v75
    v_fmac_f32 v13, v76, v77
    v_fmac_f32 v13, v78, v79
    v_fmac_f32 v13, v80, v81
    v_fmac_f32 v13, v82, v83
    v_fmac_f32 v13, v84, v85
    v_fmac_f32 v13, v86, v87
    v_fmac_f32 v13, v88, v89
    v_fmac_f32 v13, v90, v91
    v_fmac_f32 v13, v92, v93
    v_fmac_f32 v13, v94, v95
    v_rcp_f32 v13, v13
    s_cmp_eq_u32 s64, 0
    s_cselect_b64 vcc, -1, 0
    v_mov_b32 v16, v32
    v_mov_b32 v17, v34
    v_mov_b32 v18, v36
    v_mov_b32 v19, v38
    s_cmp_eq_u32 s64, 1
    s_cselect_b64 vcc, -1, 0
    v_cndmask_b32 v16, v16, v40, vcc
    v_cndmask_b32 v17, v17, v42, vcc
    v_cndmask_b32 v18, v18, v44, vcc
    v_cndmask_b32 v19, v19, v46, vcc
    s_cmp_eq_u32 s64, 2
    s_cselect_b64 vcc, -1, 0
    v_cndmask_b32 v16, v16, v48, vcc
    v_cndmask_b32 v17, v17, v50, vcc
    v_cndmask_b32 v18, v18, v52, vcc
    v_cndmask_b32 v19, v19, v54, vcc
    s_cmp_eq_u32 s64, 3
    s_cselect_b64 vcc, -1, 0
    v_cndmask_b32 v16, v16, v56, vcc
    v_cndmask_b32 v17, v17, v58, vcc
    v_cndmask_b32 v18, v18, v60, vcc
    v_cndmask_b32 v19, v19, v62, vcc
    s_cmp_eq_u32 s64, 4
    s_cselect_b64 vcc, -1, 0
    v_cndmask_b32 v16, v16, v64, vcc
    v_cndmask_b32 v17, v17, v66, vcc
    v_cndmask_b32 v18, v18, v68, vcc
    v_cndmask_b32 v19, v19, v70, vcc
    s_cmp_eq_u32 s64, 5
    s_cselect_b64 vcc, -1, 0
    v_cndmask_b32 v16, v16, v72, vcc
    v_cndmask_b32 v17, v17, v74, vcc
    v_cndmask_b32 v18, v18, v76, vcc
    v_cndmask_b32 v19, v19, v78, vcc
    s_cmp_eq_u32 s64, 6
    s_cselect_b64 vcc, -1, 0
    v_cndmask_b32 v16, v16, v80, vcc
    v_cndmask_b32 v17, v17, v82, vcc
    v_cndmask_b32 v18, v18, v84, vcc
    v_cndmask_b32 v19, v19, v86, vcc
    s_cmp_eq_u32 s64, 7
    s_cselect_b64 vcc, -1, 0
    v_cndmask_b32 v16, v16, v88, vcc
    v_cndmask_b32 v17, v17, v90, vcc
    v_cndmask_b32 v18, v18, v92, vcc
    v_cndmask_b32 v19, v19, v94, vcc
    v_mul_f32 v16, v16, v13
    v_mul_f32 v17, v17, v13
    v_mul_f32 v18, v18, v13
    v_mul_f32 v19, v19, v13
    s_waitcnt vmcnt(0)
    v_lshlrev_b32 v28, 16, v96
    v_and_b32 v29, 0xffff0000, v96
    v_mul_f32 v20, v16, v28
    v_mul_f32 v21, v16, v29
    v_lshlrev_b32 v28, 16, v97
    v_and_b32 v29, 0xffff0000, v97
    v_mul_f32 v22, v16, v28
    v_mul_f32 v23, v16, v29
    v_lshlrev_b32 v28, 16, v98
    v_and_b32 v29, 0xffff0000, v98
    v_mul_f32 v24, v16, v28
    v_mul_f32 v25, v16, v29
    v_lshlrev_b32 v28, 16, v99
    v_and_b32 v29, 0xffff0000, v99
    v_mul_f32 v26, v16, v28
    v_mul_f32 v27, v16, v29
    v_lshlrev_b32 v28, 16, v100
    v_and_b32 v29, 0xffff0000, v100
    v_fmac_f32 v20, v17, v28
    v_fmac_f32 v21, v17, v29
    v_lshlrev_b32 v28, 16, v101
    v_and_b32 v29, 0xffff0000, v101
    v_fmac_f32 v22, v17, v28
    v_fmac_f32 v23, v17, v29
    v_lshlrev_b32 v28, 16, v102
    v_and_b32 v29, 0xffff0000, v102
    v_fmac_f32 v24, v17, v28
    v_fmac_f32 v25, v17, v29
    v_lshlrev_b32 v28, 16, v103
    v_and_b32 v29, 0xffff0000, v103
    v_fmac_f32 v26, v17, v28
    v_fmac_f32 v27, v17, v29
    v_lshlrev_b32 v28, 16, v104
    v_and_b32 v29, 0xffff0000, v104
    v_fmac_f32 v20, v18, v28
    v_fmac_f32 v21, v18, v29
    v_lshlrev_b32 v28, 16, v105
    v_and_b32 v29, 0xffff0000, v105
    v_fmac_f32 v22, v18, v28
    v_fmac_f32 v23, v18, v29
    v_lshlrev_b32 v28, 16, v106
    v_and_b32 v29, 0xffff0000, v106
    v_fmac_f32 v24, v18, v28
    v_fmac_f32 v25, v18, v29
    v_lshlrev_b32 v28, 16, v107
    v_and_b32 v29, 0xffff0000, v107
    v_fmac_f32 v26, v18, v28
    v_fmac_f32 v27, v18, v29
    v_lshlrev_b32 v28, 16, v108
    v_and_b32 v29, 0xffff0000, v108
    v_fmac_f32 v20, v19, v28
    v_fmac_f32 v21, v19, v29
    v_lshlrev_b32 v28, 16, v109
    v_and_b32 v29, 0xffff0000, v109
    v_fmac_f32 v22, v19, v28
    v_fmac_f32 v23, v19, v29
    v_lshlrev_b32 v28, 16, v110
    v_and_b32 v29, 0xffff0000, v110
    v_fmac_f32 v24, v19, v28
    v_fmac_f32 v25, v19, v29
    v_lshlrev_b32 v28, 16, v111
    v_and_b32 v29, 0xffff0000, v111
    v_fmac_f32 v26, v19, v28
    v_fmac_f32 v27, v19, v29
    v_lshlrev_b32 v8, 5, v0
    ds_write_b128 v8, v[20:23] offset:32768
    ds_write_b128 v8, v[24:27] offset:32784
    s_waitcnt lgkmcnt(0)
    s_barrier
    v_and_b32 v9, 255, v0
    v_lshlrev_b32 v8, 3, v9
    ds_read_b64 v[32:33], v8 offset:32768
    ds_read_b64 v[34:35], v8 offset:34816
    ds_read_b64 v[36:37], v8 offset:36864
    ds_read_b64 v[38:39], v8 offset:38912
    ds_read_b64 v[40:41], v8 offset:40960
    ds_read_b64 v[42:43], v8 offset:43008
    ds_read_b64 v[44:45], v8 offset:45056
    ds_read_b64 v[46:47], v8 offset:47104
    s_waitcnt lgkmcnt(0)
    v_add_f32 v32, v32, v34
    v_add_f32 v33, v33, v35
    v_add_f32 v32, v32, v36
    v_add_f32 v33, v33, v37
    v_add_f32 v32, v32, v38
    v_add_f32 v33, v33, v39
    v_add_f32 v32, v32, v40
    v_add_f32 v33, v33, v41
    v_add_f32 v32, v32, v42
    v_add_f32 v33, v33, v43
    v_add_f32 v32, v32, v44
    v_add_f32 v33, v33, v45
    v_add_f32 v32, v32, v46
    v_add_f32 v33, v33, v47
    v_cvt_pk_bf16_f32 v16, v32, v33
    v_lshlrev_b32 v8, 2, v0
    ds_write_b32 v8, v16 offset:8192
    s_waitcnt lgkmcnt(0)
    s_barrier
    v_lshrrev_b32 v8, 3, v2
    v_lshlrev_b32 v8, 10, v8
    v_lshlrev_b32 v9, 5, v3
    v_add_u32 v8, v8, v9
    s_lshl_b32 s66, s64, 7
    v_add_u32 v8, s66, v8
    ds_read_b128 v[16:19], v8 offset:8192
    ds_read_b128 v[20:23], v8 offset:8208
    s_waitcnt lgkmcnt(0)
    v_perm_b32 v32, v16, v16, s80
    v_and_b32 v28, v32, v4
    v_and_b32 v29, v32, v5
    v_and_b32 v30, v32, v6
    v_and_b32 v31, v32, v7
    s_nop 1
    v_mfma_f32_16x16x32_bf16 v[24:27], v[28:31], v[128:131], 0
    v_perm_b32 v32, v16, v16, s81
    v_and_b32 v28, v32, v4
    v_and_b32 v29, v32, v5
    v_and_b32 v30, v32, v6
    v_and_b32 v31, v32, v7
    s_nop 1
    v_mfma_f32_16x16x32_bf16 v[24:27], v[28:31], v[132:135], v[24:27]
    v_perm_b32 v32, v17, v17, s80
    v_and_b32 v28, v32, v4
    v_and_b32 v29, v32, v5
    v_and_b32 v30, v32, v6
    v_and_b32 v31, v32, v7
    s_nop 1
    v_mfma_f32_16x16x32_bf16 v[24:27], v[28:31], v[136:139], v[24:27]
    v_perm_b32 v32, v17, v17, s81
    v_and_b32 v28, v32, v4
    v_and_b32 v29, v32, v5
    v_and_b32 v30, v32, v6
    v_and_b32 v31, v32, v7
    s_nop 1
    v_mfma_f32_16x16x32_bf16 v[24:27], v[28:31], v[140:143], v[24:27]
    v_perm_b32 v32, v18, v18, s80
    v_and_b32 v28, v32, v4
    v_and_b32 v29, v32, v5
    v_and_b32 v30, v32, v6
    v_and_b32 v31, v32, v7
    s_nop 1
    v_mfma_f32_16x16x32_bf16 v[24:27], v[28:31], v[144:147], v[24:27]
    v_perm_b32 v32, v18, v18, s81
    v_and_b32 v28, v32, v4
    v_and_b32 v29, v32, v5
    v_and_b32 v30, v32, v6
    v_and_b32 v31, v32, v7
    s_nop 1
    v_mfma_f32_16x16x32_bf16 v[24:27], v[28:31], v[148:151], v[24:27]
    v_perm_b32 v32, v19, v19, s80
    v_and_b32 v28, v32, v4
    v_and_b32 v29, v32, v5
    v_and_b32 v30, v32, v6
    v_and_b32 v31, v32, v7
    s_nop 1
    v_mfma_f32_16x16x32_bf16 v[24:27], v[28:31], v[152:155], v[24:27]
    v_perm_b32 v32, v19, v19, s81
    v_and_b32 v28, v32, v4
    v_and_b32 v29, v32, v5
    v_and_b32 v30, v32, v6
    v_and_b32 v31, v32, v7
    s_nop 1
    v_mfma_f32_16x16x32_bf16 v[24:27], v[28:31], v[156:159], v[24:27]
    v_perm_b32 v32, v20, v20, s80
    v_and_b32 v28, v32, v4
    v_and_b32 v29, v32, v5
    v_and_b32 v30, v32, v6
    v_and_b32 v31, v32, v7
    s_nop 1
    v_mfma_f32_16x16x32_bf16 v[24:27], v[28:31], v[160:163], v[24:27]
    v_perm_b32 v32, v20, v20, s81
    v_and_b32 v28, v32, v4
    v_and_b32 v29, v32, v5
    v_and_b32 v30, v32, v6
    v_and_b32 v31, v32, v7
    s_nop 1
    v_mfma_f32_16x16x32_bf16 v[24:27], v[28:31], v[164:167], v[24:27]
    v_perm_b32 v32, v21, v21, s80
    v_and_b32 v28, v32, v4
    v_and_b32 v29, v32, v5
    v_and_b32 v30, v32, v6
    v_and_b32 v31, v32, v7
    s_nop 1
    v_mfma_f32_16x16x32_bf16 v[24:27], v[28:31], v[168:171], v[24:27]
    v_perm_b32 v32, v21, v21, s81
    v_and_b32 v28, v32, v4
    v_and_b32 v29, v32, v5
    v_and_b32 v30, v32, v6
    v_and_b32 v31, v32, v7
    s_nop 1
    v_mfma_f32_16x16x32_bf16 v[24:27], v[28:31], v[172:175], v[24:27]
    v_perm_b32 v32, v22, v22, s80
    v_and_b32 v28, v32, v4
    v_and_b32 v29, v32, v5
    v_and_b32 v30, v32, v6
    v_and_b32 v31, v32, v7
    s_nop 1
    v_mfma_f32_16x16x32_bf16 v[24:27], v[28:31], v[176:179], v[24:27]
    v_perm_b32 v32, v22, v22, s81
    v_and_b32 v28, v32, v4
    v_and_b32 v29, v32, v5
    v_and_b32 v30, v32, v6
    v_and_b32 v31, v32, v7
    s_nop 1
    v_mfma_f32_16x16x32_bf16 v[24:27], v[28:31], v[180:183], v[24:27]
    v_perm_b32 v32, v23, v23, s80
    v_and_b32 v28, v32, v4
    v_and_b32 v29, v32, v5
    v_and_b32 v30, v32, v6
    v_and_b32 v31, v32, v7
    s_nop 1
    v_mfma_f32_16x16x32_bf16 v[24:27], v[28:31], v[184:187], v[24:27]
    v_perm_b32 v32, v23, v23, s81
    v_and_b32 v28, v32, v4
    v_and_b32 v29, v32, v5
    v_and_b32 v30, v32, v6
    v_and_b32 v31, v32, v7
    s_nop 1
    v_mfma_f32_16x16x32_bf16 v[24:27], v[28:31], v[188:191], v[24:27]
    v_lshrrev_b32 v8, 1, v3
    v_lshlrev_b32 v8, 9, v8
    v_lshlrev_b32 v9, 5, v2
    v_add_u32 v8, v8, v9
    v_and_b32 v9, 1, v3
    v_lshlrev_b32 v9, 4, v9
    v_add_u32 v8, v8, v9
    s_lshl_b32 s66, s64, 10
    v_add_u32 v8, s66, v8
    s_nop 7
    ds_write_b128 v8, v[24:27] offset:0
    s_waitcnt lgkmcnt(0)
    s_barrier
    v_and_b32 v8, 255, v0
    v_lshlrev_b32 v9, 2, v8
    ds_read_b32 v16, v9 offset:0
    ds_read_b32 v17, v9 offset:1024
    ds_read_b32 v18, v9 offset:2048
    ds_read_b32 v19, v9 offset:3072
    ds_read_b32 v20, v9 offset:4096
    ds_read_b32 v21, v9 offset:5120
    ds_read_b32 v22, v9 offset:6144
    ds_read_b32 v23, v9 offset:7168
    s_waitcnt lgkmcnt(0)
    v_add_f32 v16, v16, v17
    v_add_f32 v16, v16, v18
    v_add_f32 v16, v16, v19
    v_add_f32 v16, v16, v20
    v_add_f32 v16, v16, v21
    v_add_f32 v16, v16, v22
    v_add_f32 v16, v16, v23
    v_cvt_pk_bf16_f32 v16, v16, v16
    v_lshlrev_b32 v9, 1, v8
    ds_write_b16 v9, v16 offset:10240
    s_waitcnt lgkmcnt(0)
    s_barrier
    s_and_b32 s67, s64, 3
    s_lshr_b32 s68, s64, 2
    v_lshlrev_b32 v8, 5, v3
    s_lshl_b32 s66, s68, 7
    v_add_u32 v8, s66, v8
    v_lshrrev_b32 v9, 3, v2
    v_lshlrev_b32 v9, 8, v9
    v_add_u32 v8, v8, v9
    ds_read_b128 v[16:19], v8 offset:10240
    ds_read_b128 v[20:23], v8 offset:10256
    s_waitcnt lgkmcnt(0)
    v_perm_b32 v32, v16, v16, s80
    v_and_b32 v28, v32, v4
    v_and_b32 v29, v32, v5
    v_and_b32 v30, v32, v6
    v_and_b32 v31, v32, v7
    s_nop 1
    v_mfma_f32_16x16x32_bf16 v[24:27], v[28:31], v[192:195], 0
    v_perm_b32 v32, v16, v16, s81
    v_and_b32 v28, v32, v4
    v_and_b32 v29, v32, v5
    v_and_b32 v30, v32, v6
    v_and_b32 v31, v32, v7
    s_nop 1
    v_mfma_f32_16x16x32_bf16 v[24:27], v[28:31], v[196:199], v[24:27]
    v_perm_b32 v32, v17, v17, s80
    v_and_b32 v28, v32, v4
    v_and_b32 v29, v32, v5
    v_and_b32 v30, v32, v6
    v_and_b32 v31, v32, v7
    s_nop 1
    v_mfma_f32_16x16x32_bf16 v[24:27], v[28:31], v[200:203], v[24:27]
    v_perm_b32 v32, v17, v17, s81
    v_and_b32 v28, v32, v4
    v_and_b32 v29, v32, v5
    v_and_b32 v30, v32, v6
    v_and_b32 v31, v32, v7
    s_nop 1
    v_mfma_f32_16x16x32_bf16 v[24:27], v[28:31], v[204:207], v[24:27]
    v_perm_b32 v32, v18, v18, s80
    v_and_b32 v28, v32, v4
    v_and_b32 v29, v32, v5
    v_and_b32 v30, v32, v6
    v_and_b32 v31, v32, v7
    s_nop 1
    v_mfma_f32_16x16x32_bf16 v[24:27], v[28:31], v[208:211], v[24:27]
    v_perm_b32 v32, v18, v18, s81
    v_and_b32 v28, v32, v4
    v_and_b32 v29, v32, v5
    v_and_b32 v30, v32, v6
    v_and_b32 v31, v32, v7
    s_nop 1
    v_mfma_f32_16x16x32_bf16 v[24:27], v[28:31], v[212:215], v[24:27]
    v_perm_b32 v32, v19, v19, s80
    v_and_b32 v28, v32, v4
    v_and_b32 v29, v32, v5
    v_and_b32 v30, v32, v6
    v_and_b32 v31, v32, v7
    s_nop 1
    v_mfma_f32_16x16x32_bf16 v[24:27], v[28:31], v[216:219], v[24:27]
    v_perm_b32 v32, v19, v19, s81
    v_and_b32 v28, v32, v4
    v_and_b32 v29, v32, v5
    v_and_b32 v30, v32, v6
    v_and_b32 v31, v32, v7
    s_nop 1
    v_mfma_f32_16x16x32_bf16 v[24:27], v[28:31], v[220:223], v[24:27]
    v_perm_b32 v32, v20, v20, s80
    v_and_b32 v28, v32, v4
    v_and_b32 v29, v32, v5
    v_and_b32 v30, v32, v6
    v_and_b32 v31, v32, v7
    s_nop 1
    v_mfma_f32_16x16x32_bf16 v[24:27], v[28:31], v[224:227], v[24:27]
    v_perm_b32 v32, v20, v20, s81
    v_and_b32 v28, v32, v4
    v_and_b32 v29, v32, v5
    v_and_b32 v30, v32, v6
    v_and_b32 v31, v32, v7
    s_nop 1
    v_mfma_f32_16x16x32_bf16 v[24:27], v[28:31], v[228:231], v[24:27]
    v_perm_b32 v32, v21, v21, s80
    v_and_b32 v28, v32, v4
    v_and_b32 v29, v32, v5
    v_and_b32 v30, v32, v6
    v_and_b32 v31, v32, v7
    s_nop 1
    v_mfma_f32_16x16x32_bf16 v[24:27], v[28:31], v[232:235], v[24:27]
    v_perm_b32 v32, v21, v21, s81
    v_and_b32 v28, v32, v4
    v_and_b32 v29, v32, v5
    v_and_b32 v30, v32, v6
    v_and_b32 v31, v32, v7
    s_nop 1
    v_mfma_f32_16x16x32_bf16 v[24:27], v[28:31], v[236:239], v[24:27]
    v_perm_b32 v32, v22, v22, s80
    v_and_b32 v28, v32, v4
    v_and_b32 v29, v32, v5
    v_and_b32 v30, v32, v6
    v_and_b32 v31, v32, v7
    s_nop 1
    v_mfma_f32_16x16x32_bf16 v[24:27], v[28:31], v[240:243], v[24:27]
    v_perm_b32 v32, v22, v22, s81
    v_and_b32 v28, v32, v4
    v_and_b32 v29, v32, v5
    v_and_b32 v30, v32, v6
    v_and_b32 v31, v32, v7
    s_nop 1
    v_mfma_f32_16x16x32_bf16 v[24:27], v[28:31], v[244:247], v[24:27]
    v_perm_b32 v32, v23, v23, s80
    v_and_b32 v28, v32, v4
    v_and_b32 v29, v32, v5
    v_and_b32 v30, v32, v6
    v_and_b32 v31, v32, v7
    s_nop 1
    v_mfma_f32_16x16x32_bf16 v[24:27], v[28:31], v[248:251], v[24:27]
    v_perm_b32 v32, v23, v23, s81
    v_and_b32 v28, v32, v4
    v_and_b32 v29, v32, v5
    v_and_b32 v30, v32, v6
    v_and_b32 v31, v32, v7
    s_nop 1
    v_mfma_f32_16x16x32_bf16 v[24:27], v[28:31], v[252:255], v[24:27]
    v_lshrrev_b32 v8, 1, v3
    v_lshlrev_b32 v8, 11, v8
    v_lshlrev_b32 v9, 5, v2
    v_add_u32 v8, v8, v9
    v_and_b32 v9, 1, v3
    v_lshlrev_b32 v9, 4, v9
    v_add_u32 v8, v8, v9
    s_lshl_b32 s66, s68, 12
    s_lshl_b32 s69, s67, 9
    s_add_u32 s66, s66, s69
    v_add_u32 v8, s66, v8
    s_nop 7
    ds_write_b128 v8, v[24:27] offset:12288
    s_waitcnt lgkmcnt(0)
    s_barrier
    v_lshlrev_b32 v8, 2, v0
    ds_read_b32 v12, v8 offset:12288
    ds_read_b32 v13, v8 offset:16384
    s_waitcnt lgkmcnt(0)
    v_add_f32 v12, v12, v13
    buffer_store_dword v12, v8, s[60:63], 0 offen sc1
L_main_end:
    s_endpgm
.p2align 8
final_kernel:
    s_cmp_ge_u32 s2, 32
    s_cbranch_scc1 L_final_end
    s_load_dwordx16 s[16:31], s[0:1], 0
    s_load_dwordx8 s[32:39], s[0:1], 64
    s_load_dwordx4 s[40:43], s[0:1], 96
    v_and_b32 v1, 63, v0
    v_lshrrev_b32 v8, 6, v0
    v_and_b32 v2, 15, v1
    v_readfirstlane_b32 s64, v8
    v_lshrrev_b32 v3, 4, v1
    s_mov_b32 s65, 0x3e0293ee
    s_waitcnt lgkmcnt(0)
    s_and_b32 s74, s2, 7
    s_lshr_b32 s73, s2, 3
    s_and_b32 s73, s73, 1
    s_mov_b32 s60, s38
    s_mov_b32 s61, s39
    s_mov_b32 s62, 0x1000
    s_mov_b32 s63, 0x00020000
    s_cmp_ge_u32 s2, 16
    s_cbranch_scc1 L_final_B
    s_add_u32 s44, s42, 0x420000
    s_addc_u32 s45, s43, 0
    s_mov_b32 s46, 0x20000
    s_mov_b32 s47, 0x00020000
    s_lshl_b32 s66, s73, 11
    s_lshl_b32 s67, s74, 8
    s_add_u32 s66, s66, s67
    s_lshl_b32 s67, s64, 14
    s_add_u32 s66, s66, s67
    v_lshlrev_b32 v8, 2, v1
    v_add_u32 v8, s66, v8
    s_mov_b32 s67, 4096
    s_mov_b32 s68, 8192
    s_mov_b32 s69, 12288
    buffer_load_dword v16, v8, s[44:47], 0 offen
    buffer_load_dword v17, v8, s[44:47], s67 offen
    buffer_load_dword v18, v8, s[44:47], s68 offen
    buffer_load_dword v19, v8, s[44:47], s69 offen
    s_waitcnt vmcnt(0)
    v_add_f32 v16, v16, v17
    v_add_f32 v18, v18, v19
    v_add_f32 v12, v16, v18
    s_mov_b32 s71, 0
    s_branch L_final_red
L_final_B:
    s_add_u32 s44, s42, 0x440000
    s_addc_u32 s45, s43, 0
    s_mov_b32 s46, 0x80000
    s_mov_b32 s47, 0x00020000
    s_add_u32 s48, s42, 0x4c0000
    s_addc_u32 s49, s43, 0
    s_mov_b32 s50, 0x800
    s_mov_b32 s51, 0x00020000
    s_lshl_b32 s66, s73, 5
    s_lshl_b32 s67, s64, 2
    s_add_u32 s66, s66, s67
    s_lshl_b32 s67, s66, 13
    s_lshl_b32 s68, s74, 8
    s_add_u32 s67, s67, s68
    v_lshlrev_b32 v8, 2, v1
    v_add_u32 v8, s67, v8
    s_lshl_b32 s67, s66, 5
    v_mov_b32 v9, s67
    buffer_load_dwordx4 v[32:35], v9, s[48:51], 0 offen offset:0
    buffer_load_dwordx4 v[36:39], v9, s[48:51], 0 offen offset:16
    buffer_load_dwordx4 v[40:43], v9, s[48:51], 0 offen offset:32
    buffer_load_dwordx4 v[44:47], v9, s[48:51], 0 offen offset:48
    buffer_load_dwordx4 v[48:51], v9, s[48:51], 0 offen offset:64
    buffer_load_dwordx4 v[52:55], v9, s[48:51], 0 offen offset:80
    buffer_load_dwordx4 v[56:59], v9, s[48:51], 0 offen offset:96
    buffer_load_dwordx4 v[60:63], v9, s[48:51], 0 offen offset:112
    s_mov_b32 s67, 0
    buffer_load_dword v64, v8, s[44:47], s67 offen
    s_add_u32 s67, s67, 2048
    buffer_load_dword v65, v8, s[44:47], s67 offen
    s_add_u32 s67, s67, 2048
    buffer_load_dword v66, v8, s[44:47], s67 offen
    s_add_u32 s67, s67, 4096
    buffer_load_dword v68, v8, s[44:47], s67 offen
    s_add_u32 s67, s67, 2048
    buffer_load_dword v69, v8, s[44:47], s67 offen
    s_add_u32 s67, s67, 2048
    buffer_load_dword v70, v8, s[44:47], s67 offen
    s_add_u32 s67, s67, 4096
    buffer_load_dword v72, v8, s[44:47], s67 offen
    s_add_u32 s67, s67, 2048
    buffer_load_dword v73, v8, s[44:47], s67 offen
    s_add_u32 s67, s67, 2048
    buffer_load_dword v74, v8, s[44:47], s67 offen
    s_add_u32 s67, s67, 4096
    buffer_load_dword v76, v8, s[44:47], s67 offen
    s_add_u32 s67, s67, 2048
    buffer_load_dword v77, v8, s[44:47], s67 offen
    s_add_u32 s67, s67, 2048
    buffer_load_dword v78, v8, s[44:47], s67 offen
    s_waitcnt vmcnt(0)
    v_mov_b32 v12, 0
    v_max3_f32 v16, v32, v34, v36
    v_sub_f32 v32, v32, v16
    v_mul_f32 v32, s65, v32
    v_exp_f32 v32, v32
    v_sub_f32 v34, v34, v16
    v_mul_f32 v34, s65, v34
    v_exp_f32 v34, v34
    v_sub_f32 v36, v36, v16
    v_mul_f32 v36, s65, v36
    v_exp_f32 v36, v36
    s_nop 0
    v_mul_f32 v17, v32, v33
    v_mul_f32 v18, v32, v64
    v_fmac_f32 v17, v34, v35
    v_fmac_f32 v18, v34, v65
    v_fmac_f32 v17, v36, v37
    v_fmac_f32 v18, v36, v66
    v_rcp_f32 v17, v17
    s_nop 0
    v_fmac_f32 v12, v18, v17
    v_max3_f32 v16, v40, v42, v44
    v_sub_f32 v40, v40, v16
    v_mul_f32 v40, s65, v40
    v_exp_f32 v40, v40
    v_sub_f32 v42, v42, v16
    v_mul_f32 v42, s65, v42
    v_exp_f32 v42, v42
    v_sub_f32 v44, v44, v16
    v_mul_f32 v44, s65, v44
    v_exp_f32 v44, v44
    s_nop 0
    v_mul_f32 v17, v40, v41
    v_mul_f32 v18, v40, v68
    v_fmac_f32 v17, v42, v43
    v_fmac_f32 v18, v42, v69
    v_fmac_f32 v17, v44, v45
    v_fmac_f32 v18, v44, v70
    v_rcp_f32 v17, v17
    s_nop 0
    v_fmac_f32 v12, v18, v17
    v_max3_f32 v16, v48, v50, v52
    v_sub_f32 v48, v48, v16
    v_mul_f32 v48, s65, v48
    v_exp_f32 v48, v48
    v_sub_f32 v50, v50, v16
    v_mul_f32 v50, s65, v50
    v_exp_f32 v50, v50
    v_sub_f32 v52, v52, v16
    v_mul_f32 v52, s65, v52
    v_exp_f32 v52, v52
    s_nop 0
    v_mul_f32 v17, v48, v49
    v_mul_f32 v18, v48, v72
    v_fmac_f32 v17, v50, v51
    v_fmac_f32 v18, v50, v73
    v_fmac_f32 v17, v52, v53
    v_fmac_f32 v18, v52, v74
    v_rcp_f32 v17, v17
    s_nop 0
    v_fmac_f32 v12, v18, v17
    v_max3_f32 v16, v56, v58, v60
    v_sub_f32 v56, v56, v16
    v_mul_f32 v56, s65, v56
    v_exp_f32 v56, v56
    v_sub_f32 v58, v58, v16
    v_mul_f32 v58, s65, v58
    v_exp_f32 v58, v58
    v_sub_f32 v60, v60, v16
    v_mul_f32 v60, s65, v60
    v_exp_f32 v60, v60
    s_nop 0
    v_mul_f32 v17, v56, v57
    v_mul_f32 v18, v56, v76
    v_fmac_f32 v17, v58, v59
    v_fmac_f32 v18, v58, v77
    v_fmac_f32 v17, v60, v61
    v_fmac_f32 v18, v60, v78
    v_rcp_f32 v17, v17
    s_nop 0
    v_fmac_f32 v12, v18, v17
    s_mov_b32 s71, 1024
L_final_red:
    v_lshlrev_b32 v8, 2, v0
    ds_write_b32 v8, v12
    s_waitcnt lgkmcnt(0)
    s_barrier
    s_cmp_lg_u32 s64, 0
    s_cbranch_scc1 L_final_end
    ds_read_b32 v16, v8 offset:0
    ds_read_b32 v17, v8 offset:256
    ds_read_b32 v18, v8 offset:512
    ds_read_b32 v19, v8 offset:768
    ds_read_b32 v20, v8 offset:1024
    ds_read_b32 v21, v8 offset:1280
    ds_read_b32 v22, v8 offset:1536
    ds_read_b32 v23, v8 offset:1792
    s_waitcnt lgkmcnt(0)
    v_add_f32 v16, v16, v17
    v_add_f32 v16, v16, v18
    v_add_f32 v16, v16, v19
    v_add_f32 v16, v16, v20
    v_add_f32 v16, v16, v21
    v_add_f32 v16, v16, v22
    v_add_f32 v16, v16, v23
    v_cvt_pk_bf16_f32 v16, v16, v16
    s_lshl_b32 s66, s73, 11
    s_lshl_b32 s67, s74, 7
    s_add_u32 s66, s66, s67
    s_add_u32 s66, s66, s71
    v_lshlrev_b32 v8, 1, v1
    buffer_store_short v16, v8, s[60:63], s66 offen
L_final_end:
    s_endpgm
.section .rodata,"a"
.p2align 6
.p2align 6

.amdhsa_kernel main_kernel
  .amdhsa_next_free_vgpr 256
  .amdhsa_next_free_sgpr 100
  .amdhsa_accum_offset 256
  .amdhsa_group_segment_fixed_size 0
  .amdhsa_kernarg_size 112
  .amdhsa_user_sgpr_count 2
  .amdhsa_user_sgpr_kernarg_segment_ptr 1
  .amdhsa_system_sgpr_workgroup_id_x 1
.end_amdhsa_kernel
.p2align 6

.amdhsa_kernel final_kernel
  .amdhsa_next_free_vgpr 128
  .amdhsa_next_free_sgpr 100
  .amdhsa_accum_offset 128
  .amdhsa_group_segment_fixed_size 0
  .amdhsa_kernarg_size 112
  .amdhsa_user_sgpr_count 2
  .amdhsa_user_sgpr_kernarg_segment_ptr 1
  .amdhsa_system_sgpr_workgroup_id_x 1
.end_amdhsa_kernel
```
